```python
import torch

def _softmax(x, axis=-1):
    return torch.softmax(x, dim=axis)
def _gelu(x):
    return torch.nn.functional.gelu(x, approximate="tanh")
def _silu(x):
    return torch.nn.functional.silu(x)
def _sigmoid(x):
    return torch.sigmoid(x)
def _layernorm(x, axis=-1, eps=1e-5):
    m = x.mean(dim=axis, keepdim=True)
    v = x.var(dim=axis, keepdim=True, unbiased=False)
    return (x - m) / torch.sqrt(v + eps)
def _scatter_add(tgt, idx, src, axis=0):
    return tgt.clone().index_add_(axis, idx, src)
def _segment_sum(src, seg, n):
    out = torch.zeros((n,) + src.shape[1:], dtype=src.dtype)
    return out.index_add_(0, seg, src)
def _pad(x, pw):
    flat = tuple(v for pair in reversed(pw) for v in pair)
    return torch.nn.functional.pad(x, flat)

kernel_name = 'concat_heads__mha_block__sliding_block__prompt'

def setup_inputs():

    _w = (lambda a: (lambda t: t.to(torch.bfloat16) if t.is_floating_point() else t)(torch.as_tensor(a)))
    def _A_setup():
        B, S, D, H = 1, 2048, 640, 32
        return {
            "x": _w((lambda *s: torch.randn(*s, dtype=torch.bfloat16) * 0.2)(B, S, D)),
            "wqkv": _w((lambda *s: torch.randn(*s, dtype=torch.bfloat16) * 0.4)(D, 3 * D)),
            "wo": _w((lambda *s: torch.randn(*s, dtype=torch.bfloat16) * 0.1)(D, D)),
        }
    _A_in = _A_setup()

    def _B_setup():
        B, S, D = 1, 2048, 640
        return {
            "x": _w((lambda *s: torch.randn(*s, dtype=torch.bfloat16) * 0.4)(B, S, D)),
            "wqkv": _w((lambda *s: torch.randn(*s, dtype=torch.bfloat16) * 0.4)(D, 3 * D)),
            "wo": _w((lambda *s: torch.randn(*s, dtype=torch.bfloat16) * 0.05)(D, D)),
        }
    _B_in = _B_setup()

    return {
        "A_x": _A_in["x"],
        "A_wqkv": _A_in["wqkv"],
        "A_wo": _A_in["wo"],
        "B_x": _B_in["x"],
        "B_wqkv": _B_in["wqkv"],
        "B_wo": _B_in["wo"],
    }

def reference(A_x, A_wqkv, A_wo, B_x, B_wqkv, B_wo):
    def _A_ref(x, wqkv, wo):
        B, S, D = x.shape
        H = 32
        Dh = D // H
        qkv = (lambda x, *d: x.permute(*d))((x @ wqkv).reshape(B, S, 3, H, Dh), 2, 0, 3, 1, 4)
        q, k, v = qkv[0], qkv[1], qkv[2]
        scores = torch.einsum("bhqd,bhkd->bhqk", q, k) * (Dh ** -0.5)
        p = _softmax(scores, axis=-1)
        o = torch.einsum("bhqk,bhkd->bhqd", p, v)
        return (lambda x, *d: x.permute(*d))(o, 0, 2, 1, 3).reshape(B, S, D) @ wo

    def _B_ref(x, wqkv, wo):
        B, S, D = x.shape
        H = 32; Dh = D // H; W = 256
        qkv = (lambda x, *d: x.permute(*d))((x @ wqkv).reshape(B, S, 3, H, Dh), 2, 0, 3, 1, 4)
        q, k, v = qkv[0], qkv[1], qkv[2]
        scores = torch.einsum("bhqd,bhkd->bhqk", q, k) * (Dh ** -0.5)
        idx = torch.arange(S)
        mask = (idx[:, None] - idx[None, :] >= 0) & (idx[:, None] - idx[None, :] < W)
        scores = torch.where(mask[None, None], scores, -1e9)
        p = _softmax(scores, axis=-1)
        o = torch.einsum("bhqk,bhkd->bhqd", p, v)
        return (lambda x, *d: x.permute(*d))(o, 0, 2, 1, 3).reshape(B, S, D) @ wo

    a = _A_ref(A_x, A_wqkv, A_wo)
    b = _B_ref(B_x, B_wqkv, B_wo)
    return torch.concatenate([a, b], axis=-1)
```

```asm
; @launch kernel=qkv_kernel grid=(256,1,1) block=(512,1,1) lds=147456
; @launch kernel=attn_kernel grid=(256,1,1) block=(512,1,1) lds=163840
.amdgcn_target "amdgcn-amd-amdhsa--gfx950"
.text
.p2align 8
.type qkv_kernel,@function
qkv_kernel:
    s_cmp_ge_u32 s2, 256
    s_cbranch_scc1 L_qkv_end
    s_load_dwordx4 s[36:39], s[0:1], 0
    s_load_dwordx4 s[40:43], s[0:1], 24
    s_load_dwordx2 s[44:45], s[0:1], 64
    v_lshrrev_b32 v6, 6, v0
    v_and_b32_e64 v1, 63, v0
    v_readfirstlane_b32 s23, v6
    s_and_b32 s28, s2, 7
    s_lshr_b32 s29, s2, 3
    s_lshr_b32 s20, s28, 2
    s_bfe_u32 s21, s28, 0x10001
    s_lshl_b32 s21, s21, 3
    s_and_b32 s3, s29, 7
    s_add_u32 s21, s21, s3
    s_and_b32 s22, s28, 1
    s_lshl_b32 s22, s22, 2
    s_lshr_b32 s3, s29, 3
    s_add_u32 s22, s22, s3
    s_and_b32 s47, s23, 3
    s_add_u32 s4, s21, s22
    s_and_b32 s4, s4, 3
    s_mul_i32 s4, s4, 5
    s_add_u32 s4, s4, 1
    s_lshr_b32 s4, s4, 1
    s_sub_u32 s3, s4, 10
    s_cmp_ge_u32 s4, 10
    s_cselect_b32 s4, s3, s4
    s_lshl_b32 s28, s21, 2
    s_add_u32 s28, s28, s47
    v_lshrrev_b32_e64 v5, 4, v1
    s_cmp_lt_u32 s23, 4
    s_cbranch_scc1 L_qkv_comp
    s_mul_i32 s24, s28, 40960
    s_lshl_b32 s5, s4, 7
    v_lshrrev_b32 v8, 3, v1
    v_mul_u32_u24 v9, 1280, v8
    v_and_b32 v11, 7, v1
    v_xor_b32 v10, v5, v11
    v_lshl_add_u32 v12, v10, 4, v9
    v_xor_b32_e64 v10, 4, v10
    v_lshl_add_u32 v13, v10, 4, v9
    v_add_u32 v14, 8192, v12
    v_add_u32 v15, 27648, v13
    v_add_u32 v13, 19456, v13
    s_lshl_b32 s32, s47, 12
    s_add_u32 s32, s32, 32768
    s_mov_b32 m0, s32
    s_add_u32 s7, s24, s5
    s_waitcnt lgkmcnt(0)
    s_cmp_eq_u32 s20, 0
    s_cselect_b64 s[34:35], s[36:37], s[40:41]
    s_cselect_b64 s[68:69], s[38:39], s[42:43]
    s_mov_b32 s8, s34
    s_and_b32 s9, s35, 0xffff
    s_mov_b32 s10, 2621440
    s_mov_b32 s11, 0x20000
    buffer_load_dwordx4 v12, s[8:11], s7 offen offset:0 lds
    buffer_load_dwordx4 v13, s[8:11], s7 offen offset:1024 lds
    buffer_load_dwordx4 v14, s[8:11], s7 offen offset:2048 lds
    buffer_load_dwordx4 v15, s[8:11], s7 offen offset:3072 lds
    s_mov_b32 s12, s68
    s_and_b32 s13, s69, 0xffff
    s_mov_b32 s14, 2457600
    s_mov_b32 s15, 0x20000
    v_add_u32 v8, 0, v1
    v_mul_u32_u24 v9, 3277, v8
    v_lshrrev_b32 v9, 16, v9
    v_mul_u32_u24 v10, 20, v9
    v_sub_u32_e64 v10, v8, v10
    v_bfe_u32 v11, v9, 3, 1
    v_lshlrev_b32 v11, 1, v11
    v_xor_b32 v10, v10, v11
    v_mul_u32_u24 v11, 3840, v9
    v_lshl_add_u32 v16, v10, 4, v11
    v_add_u32_e64 v8, 64, v1
    v_mul_u32_u24 v9, 3277, v8
    v_lshrrev_b32 v9, 16, v9
    v_mul_u32_u24 v10, 20, v9
    v_sub_u32_e64 v10, v8, v10
    v_bfe_u32 v11, v9, 3, 1
    v_lshlrev_b32 v11, 1, v11
    v_xor_b32 v10, v10, v11
    v_mul_u32_u24 v11, 3840, v9
    v_lshl_add_u32 v17, v10, 4, v11
    v_subrev_u32 v17, 1024, v17
    v_add_u32 v8, 128, v1
    v_mul_u32_u24 v9, 3277, v8
    v_lshrrev_b32 v9, 16, v9
    v_mul_u32_u24 v10, 20, v9
    v_sub_u32_e64 v10, v8, v10
    v_bfe_u32 v11, v9, 3, 1
    v_lshlrev_b32 v11, 1, v11
    v_xor_b32 v10, v10, v11
    v_mul_u32_u24 v11, 3840, v9
    v_lshl_add_u32 v18, v10, 4, v11
    v_subrev_u32 v18, 2048, v18
    v_add_u32 v8, 192, v1
    v_mul_u32_u24 v9, 3277, v8
    v_lshrrev_b32 v9, 16, v9
    v_mul_u32_u24 v10, 20, v9
    v_sub_u32_e64 v10, v8, v10
    v_bfe_u32 v11, v9, 3, 1
    v_lshlrev_b32 v11, 1, v11
    v_xor_b32 v10, v10, v11
    v_mul_u32_u24 v11, 3840, v9
    v_lshl_add_u32 v19, v10, 4, v11
    v_subrev_u32 v19, 3072, v19
    v_add_u32 v8, 256, v1
    v_mul_u32_u24 v9, 3277, v8
    v_lshrrev_b32 v9, 16, v9
    v_mul_u32_u24 v10, 20, v9
    v_sub_u32_e64 v10, v8, v10
    v_bfe_u32 v11, v9, 3, 1
    v_lshlrev_b32 v11, 1, v11
    v_xor_b32 v10, v10, v11
    v_mul_u32_u24 v11, 3840, v9
    v_lshl_add_u32 v20, v10, 4, v11
    v_add_u32_e64 v8, 0, v1
    v_mul_u32_u24 v9, 5462, v8
    v_lshrrev_b32 v9, 16, v9
    v_mul_u32_u24 v10, 12, v9
    v_sub_u32_e64 v10, v8, v10
    v_bfe_u32 v11, v9, 3, 1
    v_lshlrev_b32 v11, 1, v11
    v_xor_b32 v10, v10, v11
    v_mul_u32_u24 v11, 3840, v9
    v_lshl_add_u32 v21, v10, 4, v11
    v_add_u32_e64 v8, 64, v1
    v_mul_u32_u24 v9, 5462, v8
    v_lshrrev_b32 v9, 16, v9
    v_mul_u32_u24 v10, 12, v9
    v_sub_u32_e64 v10, v8, v10
    v_bfe_u32 v11, v9, 3, 1
    v_lshlrev_b32 v11, 1, v11
    v_xor_b32 v10, v10, v11
    v_mul_u32_u24 v11, 3840, v9
    v_lshl_add_u32 v22, v10, 4, v11
    v_subrev_u32 v22, 1024, v22
    v_add_u32 v8, 128, v1
    v_mul_u32_u24 v9, 5462, v8
    v_lshrrev_b32 v9, 16, v9
    v_mul_u32_u24 v10, 12, v9
    v_sub_u32_e64 v10, v8, v10
    v_bfe_u32 v11, v9, 3, 1
    v_lshlrev_b32 v11, 1, v11
    v_xor_b32 v10, v10, v11
    v_mul_u32_u24 v11, 3840, v9
    v_lshl_add_u32 v23, v10, 4, v11
    v_subrev_u32 v23, 2048, v23
    s_mul_i32 s3, s47, 61440
    s_mul_i32 s25, s22, 320
    s_add_u32 s25, s25, s3
    s_mul_i32 s26, s22, 160
    s_add_u32 s26, s26, 2560
    s_andn2_b32 s26, s26, 63
    s_add_u32 s26, s26, s3
    s_mul_i32 s46, s47, 5120
    s_mul_i32 s27, s47, 3072
    s_add_u32 s27, s27, 20480
    s_mul_i32 s4, s4, 245760
    s_mov_b32 s71, 0
    s_mov_b32 s33, 0
    s_branch L_ld_w
L_ld_loop:
    s_add_u32 m0, s71, s32
    s_add_u32 s7, s24, s5
    buffer_load_dwordx4 v12, s[8:11], s7 offen offset:0 lds
    buffer_load_dwordx4 v13, s[8:11], s7 offen offset:1024 lds
    buffer_load_dwordx4 v14, s[8:11], s7 offen offset:2048 lds
    buffer_load_dwordx4 v15, s[8:11], s7 offen offset:3072 lds
    s_cmp_lg_u32 s33, 1
    s_cbranch_scc1 L_ld_w
    s_waitcnt vmcnt(4)
    s_barrier
L_ld_w:
    s_add_u32 s6, s71, s46
    s_mov_b32 m0, s6
    s_add_u32 s7, s25, s4
    buffer_load_dwordx4 v16, s[12:15], s7 offen offset:0 lds
    buffer_load_dwordx4 v17, s[12:15], s7 offen offset:1024 lds
    buffer_load_dwordx4 v18, s[12:15], s7 offen offset:2048 lds
    buffer_load_dwordx4 v19, s[12:15], s7 offen offset:3072 lds
    s_add_u32 m0, s6, 4096
    s_add_u32 s5, s5, 128
    buffer_load_dwordx4 v20, s[12:15], s7 offen lds
    s_add_u32 m0, s71, s27
    s_add_u32 s7, s26, s4
    buffer_load_dwordx4 v21, s[12:15], s7 offen offset:0 lds
    buffer_load_dwordx4 v22, s[12:15], s7 offen offset:1024 lds
    buffer_load_dwordx4 v23, s[12:15], s7 offen offset:2048 lds
L_ld_skip:
    s_add_u32 s4, s4, 245760
    s_cmp_eq_u32 s5, 1280
    s_cselect_b32 s5, 0, s5
    s_cselect_b32 s4, 0, s4
    s_add_u32 s71, s71, 49152
    s_cmp_eq_u32 s71, 147456
    s_cselect_b32 s71, 0, s71
    s_add_u32 s33, s33, 1
    s_cmp_lt_u32 s33, 3
    s_cbranch_scc1 L_ld_loop
    s_waitcnt vmcnt(12)
    s_barrier
    s_cmp_lt_u32 s33, 10
    s_cbranch_scc1 L_ld_loop
    s_mov_b32 s16, s44
    s_and_b32 s17, s45, 0xffff
    s_mov_b32 s18, 20973568
    s_mov_b32 s19, 0x20000
    s_lshr_b32 s72, s2, 3
    s_lshl_b32 s72, s72, 2
    s_add_u32 s72, s72, s47
    s_getpc_b64 s[74:75]
L_pf1:
    s_add_u32 s74, s74, L_qkv_epi-L_pf1
    s_addc_u32 s75, s75, (L_qkv_epi-L_pf1)>>32
    s_lshl_b32 s76, s72, 7
    s_add_u32 s76, s76, 0
    s_min_u32 s76, s76, L_text_end-L_qkv_epi-4
    s_load_dword s78, s[74:75], s76
    s_lshl_b32 s76, s72, 7
    s_add_u32 s76, s76, 16384
    s_min_u32 s76, s76, L_text_end-L_qkv_epi-4
    s_load_dword s79, s[74:75], s76
    s_waitcnt vmcnt(0)
    s_barrier
    s_cmp_ge_u32 s2, 16
    s_cbranch_scc1 L_qkv_nofl
    s_lshl_b32 s3, s2, 7
    s_add_u32 s3, s3, 20971520
    v_and_b32 v10, 31, v1
    v_lshlrev_b32 v10, 2, v10
    v_mov_b32_e64 v11, 0
    buffer_store_dword v11, v10, s[16:19], s3 offen
L_qkv_nofl:
    s_waitcnt lgkmcnt(0)
    s_barrier
    s_branch L_qkv_fin
L_qkv_comp:
    s_lshl_b32 s46, s23, 12
    s_add_u32 s46, s46, 32768
    s_lshl_b32 s29, s20, 11
    s_add_u32 s29, s29, s28
    s_lshl_b32 s3, s22, 8
    s_add_u32 s3, s3, s29
    s_mul_i32 s32, s3, 2560
    s_and_b32 s3, s22, 3
    s_lshl_b32 s3, s3, 9
    s_add_u32 s3, s3, s29
    s_mul_i32 s27, s3, 2560
    s_add_u32 s3, s27, 10485760
    s_cmp_lt_u32 s22, 4
    s_cselect_b32 s27, s3, s27
    s_cselect_b32 s30, 0x3ea52b5c, 1.0
    v_and_b32 v8, 7, v1
    v_and_b32_e64 v9, 8, v1
    v_lshl_or_b32 v8, v9, 1, v8
    s_mov_b32 s3, 163840
    v_mul_lo_u32 v9, v5, s3
    v_lshl_add_u32 v2, v8, 4, v9
    v_and_b32_e64 v8, 15, v1
    v_lshl_add_u32 v3, v8, 4, v9
    v_lshrrev_b32 v9, 1, v8
    v_xor_b32 v9, v9, v5
    v_lshlrev_b32_e64 v9, 4, v9
    v_lshl_add_u32 v12, v8, 7, v9
    v_add_u32 v12, s46, v12
    v_xor_b32 v13, 64, v12
    v_bfe_u32 v9, v1, 2, 2
    v_mul_lo_u32 v4, v9, s3
    v_mul_u32_u24 v10, 320, v5
    v_add_u32 v4, v4, v10
    v_and_b32 v10, 3, v1
    v_lshl_add_u32 v4, v10, 4, v4
    v_lshl_add_u32 v9, v5, 3, v9
    v_mul_u32_u24 v0, 320, v9
    v_mul_u32_u24 v9, 192, v9
    v_add_u32 v9, 20480, v9
    v_mul_u32_u24 v10, 40, v10
    v_and_b32 v7, 1, v5
    v_lshlrev_b32_e64 v7, 5, v7
    s_and_b32 s6, s22, 1
    s_lshl_b32 s6, s6, 5
    s_mov_b32 s33, 0
    s_mov_b32 s71, 0
    s_mov_b32 s70, 49152
    s_mov_b32 s66, 49152
    v_add_u32 v6, 0, v10
    v_xor_b32 v6, v6, v7
    v_add_u32 v14, v6, v0
    v_add_u32 v6, 8, v10
    v_xor_b32 v6, v6, v7
    v_add_u32 v15, v6, v0
    v_add_u32 v6, 16, v10
    v_xor_b32 v6, v6, v7
    v_add_u32 v16, v6, v0
    v_add_u32 v6, 24, v10
    v_xor_b32 v6, v6, v7
    v_add_u32 v17, v6, v0
    v_add_u32 v6, 32, v10
    v_xor_b32 v6, v6, v7
    v_add_u32_e64 v18, v6, v0
    v_add_u32 v6, 160, v10
    v_xor_b32 v6, v6, v7
    v_add_u32 v19, v6, v0
    v_add_u32 v6, 168, v10
    v_xor_b32 v6, v6, v7
    v_add_u32 v20, v6, v0
    v_add_u32 v6, 176, v10
    v_xor_b32 v6, v6, v7
    v_add_u32 v21, v6, v0
    v_add_u32 v6, 184, v10
    v_xor_b32 v6, v6, v7
    v_add_u32 v22, v6, v0
    v_add_u32 v6, 192, v10
    v_xor_b32 v6, v6, v7
    v_add_u32 v23, v6, v0
    v_add3_u32 v6, v10, s6, 0
    v_xor_b32 v6, v6, v7
    v_add_u32 v24, v6, v9
    v_add3_u32 v6, v10, s6, 8
    v_xor_b32 v6, v6, v7
    v_add_u32 v25, v6, v9
    v_add3_u32 v6, v10, s6, 16
    v_xor_b32 v6, v6, v7
    v_add_u32 v26, v6, v9
    v_add3_u32 v6, v10, s6, 24
    v_xor_b32 v6, v6, v7
    v_add_u32 v27, v6, v9
    v_add3_u32 v6, v10, s6, 32
    v_xor_b32 v6, v6, v7
    v_add_u32 v28, v6, v9
    v_mov_b64 v[88:89], 0
    v_mov_b64 v[90:91], 0
    v_mov_b64 v[92:93], 0
    v_mov_b64 v[94:95], 0
    v_mov_b64 v[96:97], 0
    v_mov_b64 v[98:99], 0
    v_mov_b64 v[100:101], 0
    v_mov_b64 v[102:103], 0
    v_mov_b64 v[104:105], 0
    v_mov_b64 v[106:107], 0
    v_mov_b64 v[108:109], 0
    v_mov_b64 v[110:111], 0
    v_mov_b64 v[112:113], 0
    v_mov_b64 v[114:115], 0
    v_mov_b64 v[116:117], 0
    v_mov_b64 v[118:119], 0
    v_mov_b64 v[120:121], 0
    v_mov_b64 v[122:123], 0
    v_mov_b64 v[124:125], 0
    v_mov_b64 v[126:127], 0
    v_mov_b64 v[128:129], 0
    v_mov_b64 v[130:131], 0
    v_mov_b64 v[132:133], 0
    v_mov_b64 v[134:135], 0
    v_mov_b64 v[136:137], 0
    v_mov_b64 v[138:139], 0
    v_mov_b64 v[140:141], 0
    v_mov_b64 v[142:143], 0
    v_mov_b64 v[144:145], 0
    v_mov_b64 v[146:147], 0
    v_mov_b64 v[148:149], 0
    v_mov_b64 v[150:151], 0
    v_mov_b64 v[152:153], 0
    v_mov_b64 v[154:155], 0
    v_mov_b64 v[156:157], 0
    v_mov_b64 v[158:159], 0
    v_mov_b64 v[160:161], 0
    v_mov_b64 v[162:163], 0
    v_mov_b64 v[164:165], 0
    v_mov_b64 v[166:167], 0
    v_mov_b64 v[168:169], 0
    v_mov_b64 v[170:171], 0
    v_mov_b64 v[172:173], 0
    v_mov_b64 v[174:175], 0
    v_mov_b64 v[176:177], 0
    v_mov_b64 v[178:179], 0
    v_mov_b64 v[180:181], 0
    v_mov_b64 v[182:183], 0
    v_mov_b64 v[184:185], 0
    v_mov_b64 v[186:187], 0
    v_mov_b64 v[188:189], 0
    v_mov_b64 v[190:191], 0
    v_mov_b64 v[192:193], 0
    v_mov_b64 v[194:195], 0
    v_mov_b64 v[196:197], 0
    v_mov_b64 v[198:199], 0
    v_mov_b64 v[200:201], 0
    v_mov_b64 v[202:203], 0
    v_mov_b64 v[204:205], 0
    v_mov_b64 v[206:207], 0
    s_waitcnt lgkmcnt(0)
    s_mov_b32 s16, s44
    s_and_b32 s17, s45, 0xffff
    s_mov_b32 s18, 20973568
    s_mov_b32 s19, 0x20000
    s_barrier
    ds_read_b128 v[72:75], v12 offset:0
    ds_read_b128 v[76:79], v12 offset:2048
    ds_read_b64_tr_b16 v[32:33], v14 offset:0
    ds_read_b64_tr_b16 v[34:35], v14 offset:1280
    ds_read_b64_tr_b16 v[36:37], v15 offset:0
    ds_read_b64_tr_b16 v[38:39], v15 offset:1280
    ds_read_b64_tr_b16 v[40:41], v16 offset:0
    ds_read_b64_tr_b16 v[42:43], v16 offset:1280
    ds_read_b64_tr_b16 v[44:45], v17 offset:0
    ds_read_b64_tr_b16 v[46:47], v17 offset:1280
    ds_read_b64_tr_b16 v[48:49], v18 offset:0
    ds_read_b64_tr_b16 v[50:51], v18 offset:1280
    ds_read_b64_tr_b16 v[52:53], v19 offset:0
    ds_read_b64_tr_b16 v[54:55], v19 offset:1280
.p2align 3
L_qkv_loop:
    s_waitcnt lgkmcnt(8)
    v_add_u32_e32 v12, s70, v12
    v_mfma_f32_16x16x32_bf16 v[88:91], v[32:35], v[72:75], v[88:91]
    ds_read_b64_tr_b16 v[56:57], v20 offset:0
    ds_read_b64_tr_b16 v[58:59], v20 offset:1280
    v_mfma_f32_16x16x32_bf16 v[92:95], v[32:35], v[76:79], v[92:95]
    ds_read_b64_tr_b16 v[60:61], v21 offset:0
    v_mfma_f32_16x16x32_bf16 v[96:99], v[36:39], v[72:75], v[96:99]
    ds_read_b64_tr_b16 v[62:63], v21 offset:1280
    v_mfma_f32_16x16x32_bf16 v[100:103], v[36:39], v[76:79], v[100:103]
    s_waitcnt lgkmcnt(8)
    s_nop 0
    v_mfma_f32_16x16x32_bf16 v[104:107], v[40:43], v[72:75], v[104:107]
    ds_read_b64_tr_b16 v[64:65], v22 offset:0
    ds_read_b64_tr_b16 v[66:67], v22 offset:1280
    v_mfma_f32_16x16x32_bf16 v[108:111], v[40:43], v[76:79], v[108:111]
    ds_read_b64_tr_b16 v[68:69], v23 offset:0
    ds_read_b128 v[80:83], v13 offset:0
    v_mfma_f32_16x16x32_bf16 v[112:115], v[44:47], v[72:75], v[112:115]
    ds_read_b64_tr_b16 v[70:71], v23 offset:1280
    ds_read_b128 v[84:87], v13 offset:2048
    v_mfma_f32_16x16x32_bf16 v[116:119], v[44:47], v[76:79], v[116:119]
    s_waitcnt lgkmcnt(10)
    v_add_u32_e32 v13, s70, v13
    v_mfma_f32_16x16x32_bf16 v[120:123], v[48:51], v[72:75], v[120:123]
    ds_read_b64_tr_b16 v[32:33], v24 offset:0
    ds_read_b64_tr_b16 v[34:35], v24 offset:768
    v_mfma_f32_16x16x32_bf16 v[124:127], v[48:51], v[76:79], v[124:127]
    ds_read_b64_tr_b16 v[36:37], v25 offset:0
    v_mfma_f32_16x16x32_bf16 v[128:131], v[52:55], v[72:75], v[128:131]
    ds_read_b64_tr_b16 v[38:39], v25 offset:768
    v_mfma_f32_16x16x32_bf16 v[132:135], v[52:55], v[76:79], v[132:135]
    s_waitcnt lgkmcnt(10)
    s_nop 0
    v_mfma_f32_16x16x32_bf16 v[136:139], v[56:59], v[72:75], v[136:139]
    ds_read_b64_tr_b16 v[40:41], v26 offset:0
    ds_read_b64_tr_b16 v[42:43], v26 offset:768
    v_mfma_f32_16x16x32_bf16 v[140:143], v[56:59], v[76:79], v[140:143]
    ds_read_b64_tr_b16 v[44:45], v27 offset:0
    v_mfma_f32_16x16x32_bf16 v[144:147], v[60:63], v[72:75], v[144:147]
    ds_read_b64_tr_b16 v[46:47], v27 offset:768
    v_mfma_f32_16x16x32_bf16 v[148:151], v[60:63], v[76:79], v[148:151]
    s_waitcnt lgkmcnt(9)
    s_nop 0
    v_mfma_f32_16x16x32_bf16 v[152:155], v[64:67], v[72:75], v[152:155]
    ds_read_b64_tr_b16 v[48:49], v28 offset:0
    ds_read_b64_tr_b16 v[50:51], v28 offset:768
    v_mfma_f32_16x16x32_bf16 v[156:159], v[64:67], v[76:79], v[156:159]
    ds_read_b64_tr_b16 v[52:53], v14 offset:10240
    v_mfma_f32_16x16x32_bf16 v[160:163], v[68:71], v[72:75], v[160:163]
    ds_read_b64_tr_b16 v[54:55], v14 offset:11520
    v_mfma_f32_16x16x32_bf16 v[164:167], v[68:71], v[76:79], v[164:167]
    s_waitcnt lgkmcnt(8)
    v_add_u32_e32 v14, s70, v14
    v_mfma_f32_16x16x32_bf16 v[168:171], v[72:75], v[32:35], v[168:171]
    ds_read_b64_tr_b16 v[56:57], v15 offset:10240
    ds_read_b64_tr_b16 v[58:59], v15 offset:11520
    v_mfma_f32_16x16x32_bf16 v[172:175], v[76:79], v[32:35], v[172:175]
    ds_read_b64_tr_b16 v[60:61], v16 offset:10240
    v_add_u32_e64 v15, s70, v15
    v_mfma_f32_16x16x32_bf16 v[176:179], v[72:75], v[36:39], v[176:179]
    ds_read_b64_tr_b16 v[62:63], v16 offset:11520
    v_mfma_f32_16x16x32_bf16 v[180:183], v[76:79], v[36:39], v[180:183]
    s_waitcnt lgkmcnt(8)
    v_add_u32_e32 v16, s70, v16
    v_mfma_f32_16x16x32_bf16 v[184:187], v[72:75], v[40:43], v[184:187]
    ds_read_b64_tr_b16 v[64:65], v17 offset:10240
    ds_read_b64_tr_b16 v[66:67], v17 offset:11520
    v_mfma_f32_16x16x32_bf16 v[188:191], v[76:79], v[40:43], v[188:191]
    ds_read_b64_tr_b16 v[68:69], v18 offset:10240
    v_add_u32_e64 v17, s70, v17
    v_mfma_f32_16x16x32_bf16 v[192:195], v[72:75], v[44:47], v[192:195]
    ds_read_b64_tr_b16 v[70:71], v18 offset:11520
    v_mfma_f32_16x16x32_bf16 v[196:199], v[76:79], v[44:47], v[196:199]
    s_waitcnt lgkmcnt(8)
    v_add_u32_e32 v18, s70, v18
    v_mfma_f32_16x16x32_bf16 v[200:203], v[72:75], v[48:51], v[200:203]
    ds_read_b64_tr_b16 v[32:33], v19 offset:10240
    ds_read_b64_tr_b16 v[34:35], v19 offset:11520
    v_mfma_f32_16x16x32_bf16 v[204:207], v[76:79], v[48:51], v[204:207]
    ds_read_b64_tr_b16 v[36:37], v20 offset:10240
    v_add_u32_e64 v19, s70, v19
    v_mfma_f32_16x16x32_bf16 v[88:91], v[52:55], v[80:83], v[88:91]
    ds_read_b64_tr_b16 v[38:39], v20 offset:11520
    v_mfma_f32_16x16x32_bf16 v[92:95], v[52:55], v[84:87], v[92:95]
    s_waitcnt lgkmcnt(8)
    v_add_u32_e32 v20, s70, v20
    v_mfma_f32_16x16x32_bf16 v[96:99], v[56:59], v[80:83], v[96:99]
    ds_read_b64_tr_b16 v[40:41], v21 offset:10240
    ds_read_b64_tr_b16 v[42:43], v21 offset:11520
    v_mfma_f32_16x16x32_bf16 v[100:103], v[56:59], v[84:87], v[100:103]
    ds_read_b64_tr_b16 v[44:45], v22 offset:10240
    v_add_u32_e64 v21, s70, v21
    v_mfma_f32_16x16x32_bf16 v[104:107], v[60:63], v[80:83], v[104:107]
    ds_read_b64_tr_b16 v[46:47], v22 offset:11520
    v_mfma_f32_16x16x32_bf16 v[108:111], v[60:63], v[84:87], v[108:111]
    s_waitcnt lgkmcnt(8)
    v_add_u32_e32 v22, s70, v22
    v_mfma_f32_16x16x32_bf16 v[112:115], v[64:67], v[80:83], v[112:115]
    ds_read_b64_tr_b16 v[48:49], v23 offset:10240
    ds_read_b64_tr_b16 v[50:51], v23 offset:11520
    v_mfma_f32_16x16x32_bf16 v[116:119], v[64:67], v[84:87], v[116:119]
    ds_read_b64_tr_b16 v[52:53], v24 offset:6144
    v_add_u32_e64 v23, s70, v23
    v_mfma_f32_16x16x32_bf16 v[120:123], v[68:71], v[80:83], v[120:123]
    ds_read_b64_tr_b16 v[54:55], v24 offset:6912
    v_mfma_f32_16x16x32_bf16 v[124:127], v[68:71], v[84:87], v[124:127]
    s_waitcnt lgkmcnt(8)
    v_add_u32_e32 v24, s70, v24
    v_mfma_f32_16x16x32_bf16 v[128:131], v[32:35], v[80:83], v[128:131]
    ds_read_b64_tr_b16 v[56:57], v25 offset:6144
    ds_read_b64_tr_b16 v[58:59], v25 offset:6912
    v_mfma_f32_16x16x32_bf16 v[132:135], v[32:35], v[84:87], v[132:135]
    ds_read_b64_tr_b16 v[60:61], v26 offset:6144
    v_add_u32_e64 v25, s70, v25
    v_mfma_f32_16x16x32_bf16 v[136:139], v[36:39], v[80:83], v[136:139]
    ds_read_b64_tr_b16 v[62:63], v26 offset:6912
    v_mfma_f32_16x16x32_bf16 v[140:143], v[36:39], v[84:87], v[140:143]
    s_waitcnt lgkmcnt(8)
    v_add_u32_e32 v26, s70, v26
    v_mfma_f32_16x16x32_bf16 v[144:147], v[40:43], v[80:83], v[144:147]
    ds_read_b64_tr_b16 v[64:65], v27 offset:6144
    ds_read_b64_tr_b16 v[66:67], v27 offset:6912
    v_mfma_f32_16x16x32_bf16 v[148:151], v[40:43], v[84:87], v[148:151]
    ds_read_b64_tr_b16 v[68:69], v28 offset:6144
    v_add_u32_e64 v27, s70, v27
    v_mfma_f32_16x16x32_bf16 v[152:155], v[44:47], v[80:83], v[152:155]
    ds_read_b64_tr_b16 v[70:71], v28 offset:6912
    v_mfma_f32_16x16x32_bf16 v[156:159], v[44:47], v[84:87], v[156:159]
    s_waitcnt lgkmcnt(8)
    v_add_u32_e32 v28, s70, v28
    v_mfma_f32_16x16x32_bf16 v[160:163], v[48:51], v[80:83], v[160:163]
    s_add_u32 s71, s71, 1
    s_cmp_eq_u32 s71, 2
    v_mfma_f32_16x16x32_bf16 v[164:167], v[48:51], v[84:87], v[164:167]
    s_cselect_b32 s70, 4294868992, s66
    v_mfma_f32_16x16x32_bf16 v[168:171], v[80:83], v[52:55], v[168:171]
    s_cselect_b32 s71, -1, s71
    s_add_u32 s33, s33, 1
    v_mfma_f32_16x16x32_bf16 v[172:175], v[84:87], v[52:55], v[172:175]
    s_waitcnt lgkmcnt(0)
    s_barrier
    v_mfma_f32_16x16x32_bf16 v[176:179], v[80:83], v[56:59], v[176:179]
    ds_read_b128 v[72:75], v12 offset:0
    ds_read_b128 v[76:79], v12 offset:2048
    v_mfma_f32_16x16x32_bf16 v[180:183], v[84:87], v[56:59], v[180:183]
    ds_read_b64_tr_b16 v[32:33], v14 offset:0
    ds_read_b64_tr_b16 v[34:35], v14 offset:1280
    v_mfma_f32_16x16x32_bf16 v[184:187], v[80:83], v[60:63], v[184:187]
    ds_read_b64_tr_b16 v[36:37], v15 offset:0
    ds_read_b64_tr_b16 v[38:39], v15 offset:1280
    v_mfma_f32_16x16x32_bf16 v[188:191], v[84:87], v[60:63], v[188:191]
    ds_read_b64_tr_b16 v[40:41], v16 offset:0
    ds_read_b64_tr_b16 v[42:43], v16 offset:1280
    v_mfma_f32_16x16x32_bf16 v[192:195], v[80:83], v[64:67], v[192:195]
    ds_read_b64_tr_b16 v[44:45], v17 offset:0
    ds_read_b64_tr_b16 v[46:47], v17 offset:1280
    v_mfma_f32_16x16x32_bf16 v[196:199], v[84:87], v[64:67], v[196:199]
    ds_read_b64_tr_b16 v[48:49], v18 offset:0
    ds_read_b64_tr_b16 v[50:51], v18 offset:1280
    v_mfma_f32_16x16x32_bf16 v[200:203], v[80:83], v[68:71], v[200:203]
    ds_read_b64_tr_b16 v[52:53], v19 offset:0
    ds_read_b64_tr_b16 v[54:55], v19 offset:1280
    v_mfma_f32_16x16x32_bf16 v[204:207], v[84:87], v[68:71], v[204:207]
    s_cmp_lt_u32 s33, 10
    s_cbranch_scc1 L_qkv_loop
L_qkv_epi:
    v_pk_mul_f32 v[88:89], v[88:89], s[30:31] op_sel_hi:[1,0]
    v_pk_mul_f32 v[90:91], v[90:91], s[30:31] op_sel_hi:[1,0]
    v_pk_mul_f32 v[92:93], v[92:93], s[30:31] op_sel_hi:[1,0]
    v_pk_mul_f32 v[94:95], v[94:95], s[30:31] op_sel_hi:[1,0]
    v_pk_mul_f32 v[96:97], v[96:97], s[30:31] op_sel_hi:[1,0]
    v_pk_mul_f32 v[98:99], v[98:99], s[30:31] op_sel_hi:[1,0]
    v_pk_mul_f32 v[100:101], v[100:101], s[30:31] op_sel_hi:[1,0]
    v_pk_mul_f32 v[102:103], v[102:103], s[30:31] op_sel_hi:[1,0]
    v_pk_mul_f32 v[104:105], v[104:105], s[30:31] op_sel_hi:[1,0]
    v_pk_mul_f32 v[106:107], v[106:107], s[30:31] op_sel_hi:[1,0]
    v_pk_mul_f32 v[108:109], v[108:109], s[30:31] op_sel_hi:[1,0]
    v_pk_mul_f32 v[110:111], v[110:111], s[30:31] op_sel_hi:[1,0]
    v_pk_mul_f32 v[112:113], v[112:113], s[30:31] op_sel_hi:[1,0]
    v_pk_mul_f32 v[114:115], v[114:115], s[30:31] op_sel_hi:[1,0]
    v_pk_mul_f32 v[116:117], v[116:117], s[30:31] op_sel_hi:[1,0]
    v_pk_mul_f32 v[118:119], v[118:119], s[30:31] op_sel_hi:[1,0]
    v_pk_mul_f32 v[120:121], v[120:121], s[30:31] op_sel_hi:[1,0]
    v_pk_mul_f32 v[122:123], v[122:123], s[30:31] op_sel_hi:[1,0]
    v_pk_mul_f32 v[124:125], v[124:125], s[30:31] op_sel_hi:[1,0]
    v_pk_mul_f32 v[126:127], v[126:127], s[30:31] op_sel_hi:[1,0]
    s_add_u32 s3, s27, 0
    v_cvt_pk_bf16_f32 v208, v88, v89
    v_cvt_pk_bf16_f32 v209, v90, v91
    v_cvt_pk_bf16_f32 v210, v96, v97
    v_cvt_pk_bf16_f32 v211, v98, v99
    v_cvt_pk_bf16_f32 v212, v104, v105
    v_cvt_pk_bf16_f32 v213, v106, v107
    v_cvt_pk_bf16_f32 v214, v112, v113
    v_cvt_pk_bf16_f32 v215, v114, v115
    v_cvt_pk_bf16_f32 v224, v120, v121
    v_cvt_pk_bf16_f32 v225, v122, v123
    buffer_store_dwordx4 v[208:211], v2, s[16:19], s3 offen offset:0 sc1
    buffer_store_dwordx4 v[212:215], v2, s[16:19], s3 offen offset:512 sc1
    v_cvt_pk_bf16_f32 v216, v92, v93
    v_cvt_pk_bf16_f32 v217, v94, v95
    v_cvt_pk_bf16_f32 v218, v100, v101
    v_cvt_pk_bf16_f32 v219, v102, v103
    v_cvt_pk_bf16_f32 v220, v108, v109
    v_cvt_pk_bf16_f32 v221, v110, v111
    v_cvt_pk_bf16_f32 v222, v116, v117
    v_cvt_pk_bf16_f32 v223, v118, v119
    v_cvt_pk_bf16_f32 v226, v124, v125
    v_cvt_pk_bf16_f32 v227, v126, v127
    buffer_store_dwordx4 v[216:219], v2, s[16:19], s3 offen offset:128 sc1
    buffer_store_dwordx4 v[220:223], v2, s[16:19], s3 offen offset:640 sc1
    buffer_store_dwordx4 v[224:227], v3, s[16:19], s3 offen offset:1024 sc1
    v_pk_mul_f32 v[128:129], v[128:129], s[30:31] op_sel_hi:[1,0]
    v_pk_mul_f32 v[130:131], v[130:131], s[30:31] op_sel_hi:[1,0]
    v_pk_mul_f32 v[132:133], v[132:133], s[30:31] op_sel_hi:[1,0]
    v_pk_mul_f32 v[134:135], v[134:135], s[30:31] op_sel_hi:[1,0]
    v_pk_mul_f32 v[136:137], v[136:137], s[30:31] op_sel_hi:[1,0]
    v_pk_mul_f32 v[138:139], v[138:139], s[30:31] op_sel_hi:[1,0]
    v_pk_mul_f32 v[140:141], v[140:141], s[30:31] op_sel_hi:[1,0]
    v_pk_mul_f32 v[142:143], v[142:143], s[30:31] op_sel_hi:[1,0]
    v_pk_mul_f32 v[144:145], v[144:145], s[30:31] op_sel_hi:[1,0]
    v_pk_mul_f32 v[146:147], v[146:147], s[30:31] op_sel_hi:[1,0]
    v_pk_mul_f32 v[148:149], v[148:149], s[30:31] op_sel_hi:[1,0]
    v_pk_mul_f32 v[150:151], v[150:151], s[30:31] op_sel_hi:[1,0]
    v_pk_mul_f32 v[152:153], v[152:153], s[30:31] op_sel_hi:[1,0]
    v_pk_mul_f32 v[154:155], v[154:155], s[30:31] op_sel_hi:[1,0]
    v_pk_mul_f32 v[156:157], v[156:157], s[30:31] op_sel_hi:[1,0]
    v_pk_mul_f32 v[158:159], v[158:159], s[30:31] op_sel_hi:[1,0]
    v_pk_mul_f32 v[160:161], v[160:161], s[30:31] op_sel_hi:[1,0]
    v_pk_mul_f32 v[162:163], v[162:163], s[30:31] op_sel_hi:[1,0]
    v_pk_mul_f32 v[164:165], v[164:165], s[30:31] op_sel_hi:[1,0]
    v_pk_mul_f32 v[166:167], v[166:167], s[30:31] op_sel_hi:[1,0]
    s_add_u32 s3, s27, 655360
    v_cvt_pk_bf16_f32 v228, v128, v129
    v_cvt_pk_bf16_f32 v229, v130, v131
    v_cvt_pk_bf16_f32 v230, v136, v137
    v_cvt_pk_bf16_f32 v231, v138, v139
    v_cvt_pk_bf16_f32 v232, v144, v145
    v_cvt_pk_bf16_f32 v233, v146, v147
    v_cvt_pk_bf16_f32 v234, v152, v153
    v_cvt_pk_bf16_f32 v235, v154, v155
    v_cvt_pk_bf16_f32 v244, v160, v161
    v_cvt_pk_bf16_f32 v245, v162, v163
    buffer_store_dwordx4 v[228:231], v2, s[16:19], s3 offen offset:0 sc1
    buffer_store_dwordx4 v[232:235], v2, s[16:19], s3 offen offset:512 sc1
    v_cvt_pk_bf16_f32 v236, v132, v133
    v_cvt_pk_bf16_f32 v237, v134, v135
    v_cvt_pk_bf16_f32 v238, v140, v141
    v_cvt_pk_bf16_f32 v239, v142, v143
    v_cvt_pk_bf16_f32 v240, v148, v149
    v_cvt_pk_bf16_f32 v241, v150, v151
    v_cvt_pk_bf16_f32 v242, v156, v157
    v_cvt_pk_bf16_f32 v243, v158, v159
    v_cvt_pk_bf16_f32 v246, v164, v165
    v_cvt_pk_bf16_f32 v247, v166, v167
    buffer_store_dwordx4 v[236:239], v2, s[16:19], s3 offen offset:128 sc1
    buffer_store_dwordx4 v[240:243], v2, s[16:19], s3 offen offset:640 sc1
    buffer_store_dwordx4 v[244:247], v3, s[16:19], s3 offen offset:1024 sc1
    s_waitcnt lgkmcnt(0)
    v_cvt_pk_bf16_f32 v32, v168, v169
    v_cvt_pk_bf16_f32 v33, v170, v171
    v_cvt_pk_bf16_f32 v34, v172, v173
    v_cvt_pk_bf16_f32 v35, v174, v175
    buffer_store_dwordx4 v[32:35], v4, s[16:19], s32 offen offset:1280
    v_cvt_pk_bf16_f32 v36, v176, v177
    v_cvt_pk_bf16_f32 v37, v178, v179
    v_cvt_pk_bf16_f32 v38, v180, v181
    v_cvt_pk_bf16_f32 v39, v182, v183
    buffer_store_dwordx4 v[36:39], v4, s[16:19], s32 offen offset:1344
    v_cvt_pk_bf16_f32 v40, v184, v185
    v_cvt_pk_bf16_f32 v41, v186, v187
    v_cvt_pk_bf16_f32 v42, v188, v189
    v_cvt_pk_bf16_f32 v43, v190, v191
    buffer_store_dwordx4 v[40:43], v4, s[16:19], s32 offen offset:1408
    v_cvt_pk_bf16_f32 v44, v192, v193
    v_cvt_pk_bf16_f32 v45, v194, v195
    v_cvt_pk_bf16_f32 v46, v196, v197
    v_cvt_pk_bf16_f32 v47, v198, v199
    buffer_store_dwordx4 v[44:47], v4, s[16:19], s32 offen offset:1472
    v_cvt_pk_bf16_f32 v48, v200, v201
    v_cvt_pk_bf16_f32 v49, v202, v203
    v_cvt_pk_bf16_f32 v50, v204, v205
    v_cvt_pk_bf16_f32 v51, v206, v207
    buffer_store_dwordx4 v[48:51], v4, s[16:19], s32 offen offset:1536
    s_waitcnt lgkmcnt(0)
L_qkv_fin:
L_qkv_end:
    s_endpgm
.p2align 8
.type attn_kernel,@function
attn_kernel:
    s_cmp_ge_u32 s2, 256
    s_cbranch_scc1 L_attn_end
    s_load_dwordx2 s[4:5], s[0:1], 64
    s_load_dwordx2 s[52:53], s[0:1], 16
    s_load_dwordx4 s[56:59], s[0:1], 40
    v_lshrrev_b32 v13, 6, v0
    v_and_b32 v1, 63, v0
    v_readfirstlane_b32 s14, v13
    s_and_b32 s12, s2, 7
    s_lshl_b32 s12, s12, 2
    s_bfe_u32 s3, s2, 0x20003
    s_add_u32 s12, s12, s3
    s_lshr_b32 s13, s2, 5
    s_mul_i32 s17, s12, 163840
    s_add_u32 s18, s17, 5242880
    s_lshl_b32 s15, s13, 3
    s_add_u32 s16, s15, s14
    s_mul_i32 s16, s16, 2560
    s_add_u32 s16, s16, 10485760
    s_add_u32 s19, s17, s16
    s_add_u32 s20, s18, s16
    s_mul_i32 s15, s15, 2560
    s_add_u32 s18, s18, s15
    s_sub_u32 s18, s18, 20480
    s_mul_i32 s24, s14, 5120
    v_lshlrev_b32 v7, 4, v1
    v_add_u32_e64 v2, s24, v7
    v_add_u32 v3, 4096, v2
    v_and_b32 v13, 7, v1
    v_lshlrev_b32 v8, 4, v13
    v_and_b32_e64 v13, 16, v1
    v_lshl_add_u32 v8, v13, 3, v8
    v_and_b32_e64 v13, 8, v1
    v_add3_u32 v8, v8, v13, 0
    v_add_u32 v8, 1024, v8
    s_mov_b32 s28, -1
    s_mov_b32 s29, 0
    v_mov_b32 v20, 0
    v_mov_b32 v21, 0
    s_waitcnt lgkmcnt(0)
    s_mov_b32 s8, s4
    s_and_b32 s9, s5, 0xffff
    s_mov_b32 s10, 20973568
    s_mov_b32 s11, 0x20000
    buffer_load_dwordx4 v[16:19], v7, s[8:11], s20 offen
    s_mov_b64 exec, s[28:29]
    buffer_load_dwordx2 v[20:21], v8, s[8:11], s20 offen
    s_mov_b64 exec, -1
    s_cmp_lg_u32 s13, 0
    s_cbranch_scc1 L_b_dma
    s_cmp_lt_u32 s14, 4
    s_cbranch_scc1 L_b_nodma
L_b_dma:
    s_add_u32 m0, s24, 122880
    s_add_u32 s3, s18, 0
    buffer_load_dwordx4 v2, s[8:11], s3 offen offset:0 lds
    buffer_load_dwordx4 v2, s[8:11], s3 offen offset:1024 lds
    buffer_load_dwordx4 v2, s[8:11], s3 offen offset:2048 lds
    buffer_load_dwordx4 v2, s[8:11], s3 offen offset:3072 lds
    s_add_u32 m0, s24, 126976
    s_nop 0
    buffer_load_dwordx4 v3, s[8:11], s3 offen lds
L_b_nodma:
    s_lshr_b32 s60, s2, 3
    s_lshl_b32 s60, s60, 3
    s_add_u32 s60, s60, s14
    s_getpc_b64 s[96:97]
L_pf2:
    s_add_u32 s96, s96, attn_kernel-L_pf2
    s_addc_u32 s97, s97, (attn_kernel-L_pf2)>>32
    s_lshl_b32 s98, s60, 6
    s_add_u32 s98, s98, 0
    s_min_u32 s98, s98, L_text_end-attn_kernel-4
    s_load_dword s61, s[96:97], s98
    s_mul_i32 s25, s14, 15360
    s_add_u32 s30, s17, s25
    v_and_b32 v13, 31, v1
    v_lshlrev_b32 v10, 3, v13
    v_lshrrev_b32 v14, 5, v1
    v_mul_u32_u24 v14, 320, v14
    v_lshl_add_u32 v9, v13, 4, v14
    v_add_u32 v9, 1280, v9
    s_mov_b32 s26, 0xfffff
    s_mov_b32 s27, 0xfffff
    v_mov_b32 v28, 0
    v_mov_b32 v29, 0
    v_mov_b32 v12, 0xf149f2ca
    v_mov_b32_e64 v13, 0
    s_mov_b32 s6, 0xffffffff
    s_mov_b32 s7, 0xfffffff0
    v_cndmask_b32 v128, v12, v13, s[6:7]
    v_cndmask_b32 v144, v13, v12, s[6:7]
    s_mov_b32 s6, 0xfffffffe
    s_mov_b32 s7, 0xffffffe0
    v_cndmask_b32 v129, v12, v13, s[6:7]
    v_cndmask_b32 v145, v13, v12, s[6:7]
    s_mov_b32 s6, 0xfffffffc
    s_mov_b32 s7, 0xffffffc0
    v_cndmask_b32 v130, v12, v13, s[6:7]
    v_cndmask_b32 v146, v13, v12, s[6:7]
    s_mov_b32 s6, 0xfffffff8
    s_mov_b32 s7, 0xffffff80
    v_cndmask_b32 v131, v12, v13, s[6:7]
    v_cndmask_b32 v147, v13, v12, s[6:7]
    s_mov_b32 s6, 0xffffff00
    s_mov_b32 s7, 0xfffff000
    v_cndmask_b32 v132, v12, v13, s[6:7]
    v_cndmask_b32 v148, v13, v12, s[6:7]
    s_mov_b32 s6, 0xfffffe00
    s_mov_b32 s7, 0xffffe000
    v_cndmask_b32 v133, v12, v13, s[6:7]
    v_cndmask_b32 v149, v13, v12, s[6:7]
    s_mov_b32 s6, 0xfffffc00
    s_mov_b32 s7, 0xffffc000
    v_cndmask_b32 v134, v12, v13, s[6:7]
    v_cndmask_b32 v150, v13, v12, s[6:7]
    s_mov_b32 s6, 0xfffff800
    s_mov_b32 s7, 0xffff8000
    v_cndmask_b32 v135, v12, v13, s[6:7]
    v_cndmask_b32 v151, v13, v12, s[6:7]
    s_mov_b32 s6, 0xffff0000
    s_mov_b32 s7, 0xfff00000
    v_cndmask_b32 v136, v12, v13, s[6:7]
    v_cndmask_b32 v152, v13, v12, s[6:7]
    s_mov_b32 s6, 0xfffe0000
    s_mov_b32 s7, 0xffe00000
    v_cndmask_b32 v137, v12, v13, s[6:7]
    v_cndmask_b32 v153, v13, v12, s[6:7]
    s_mov_b32 s6, 0xfffc0000
    s_mov_b32 s7, 0xffc00000
    v_cndmask_b32 v138, v12, v13, s[6:7]
    v_cndmask_b32 v154, v13, v12, s[6:7]
    s_mov_b32 s6, 0xfff80000
    s_mov_b32 s7, 0xff800000
    v_cndmask_b32 v139, v12, v13, s[6:7]
    v_cndmask_b32 v155, v13, v12, s[6:7]
    s_mov_b32 s6, 0xff000000
    s_mov_b32 s7, 0xf0000000
    v_cndmask_b32 v140, v12, v13, s[6:7]
    v_cndmask_b32 v156, v13, v12, s[6:7]
    s_mov_b32 s6, 0xfe000000
    s_mov_b32 s7, 0xe0000000
    v_cndmask_b32 v141, v12, v13, s[6:7]
    v_cndmask_b32 v157, v13, v12, s[6:7]
    s_mov_b32 s6, 0xfc000000
    s_mov_b32 s7, 0xc0000000
    v_cndmask_b32 v142, v12, v13, s[6:7]
    v_cndmask_b32 v158, v13, v12, s[6:7]
    s_mov_b32 s6, 0xf8000000
    s_mov_b32 s7, 0x80000000
    v_cndmask_b32 v143, v12, v13, s[6:7]
    v_cndmask_b32 v159, v13, v12, s[6:7]
    v_mov_b32 v40, 0
    v_mov_b32 v41, 0
    v_mov_b32 v42, 0
    v_mov_b32 v43, 0
    v_mov_b32 v44, 0
    v_mov_b32 v45, 0
    v_mov_b32 v46, 0
    v_mov_b32 v47, 0
    s_mov_b32 s6, 0x11000000
    s_mov_b32 s7, 0x11000000
    s_mov_b64 exec, s[6:7]
    v_mov_b32 v40, 0x3f803f80
    v_mov_b32 v41, 0x3f803f80
    v_mov_b32 v42, 0x3f803f80
    v_mov_b32 v43, 0x3f803f80
    v_mov_b32 v44, 0x3f803f80
    v_mov_b32 v45, 0x3f803f80
    v_mov_b32 v46, 0x3f803f80
    v_mov_b32 v47, 0x3f803f80
    s_mov_b64 exec, -1
    s_bfe_u32 s40, s2, 0x10002
    s_and_b32 s41, s2, 3
    s_lshl_b32 s41, s41, 2
    s_bfe_u32 s3, s2, 0x20003
    s_add_u32 s41, s41, s3
    s_and_b32 s47, s14, 3
    s_lshl_b32 s15, s41, 2
    s_add_u32 s15, s15, s47
    s_lshl_b32 s16, s40, 11
    s_add_u32 s16, s16, s15
    s_mul_i32 s42, s16, 2560
    s_add_u32 s42, s42, 10485760
    s_mul_i32 s43, s13, 160
    s_mul_i32 s44, s15, 81920
    s_mul_i32 s3, s40, 1280
    s_add_u32 s44, s44, s3
    s_add_u32 s44, s44, s43
    s_lshl_b32 s45, s13, 7
    s_lshl_b32 s3, s12, 2
    s_add_u32 s45, s45, s3
    s_add_u32 s45, s45, 20971520
    s_lshl_b32 s46, s40, 10
    s_lshr_b32 s3, s41, 1
    s_lshl_b32 s3, s3, 7
    s_add_u32 s46, s46, s3
    s_add_u32 s46, s46, 20971520
    s_cmp_eq_u32 s40, 0
    s_cselect_b64 s[54:55], s[52:53], s[56:57]
    s_mul_i32 s15, s47, 40
    s_mul_i32 s16, s47, 160
    s_mul_i32 s47, s47, 5120
    s_mov_b32 s32, s54
    s_and_b32 s33, s55, 0xffff
    s_mov_b32 s34, 819200
    s_mov_b32 s35, 0x20000
    s_mov_b32 s36, s58
    s_and_b32 s37, s59, 0xffff
    s_mov_b32 s38, 5242880
    s_mov_b32 s39, 0x20000
    v_add_u32_e64 v64, 0, v1
    v_mul_u32_u24 v65, 6554, v64
    v_lshrrev_b32 v65, 16, v65
    v_mul_u32_u24 v66, 10, v65
    v_sub_u32 v66, v64, v66
    v_lshrrev_b32 v64, 4, v65
    v_mul_u32_u24 v67, 20, v64
    v_and_b32 v68, 15, v65
    v_add3_u32 v67, v67, v68, s15
    v_mul_u32_u24 v67, 1280, v67
    v_lshl_add_u32 v232, v66, 4, v67
    v_lshlrev_b32_e64 v64, 2, v64
    v_bfe_u32 v67, v65, 2, 1
    v_lshl_add_u32 v64, v67, 1, v64
    v_bfe_u32 v67, v65, 3, 1
    v_add_u32 v64, v64, v67
    v_mul_u32_u24 v64, 20, v64
    v_and_b32_e64 v67, 3, v65
    v_add3_u32 v64, v64, v67, s16
    v_add_u32_e64 v64, 16, v64
    v_mul_u32_u24 v64, 1280, v64
    v_lshl_add_u32 v237, v66, 4, v64
    v_mul_u32_u24 v67, 2560, v65
    v_lshl_add_u32 v249, v66, 4, v67
    v_add_u32_e64 v64, 64, v1
    v_mul_u32_u24 v65, 6554, v64
    v_lshrrev_b32 v65, 16, v65
    v_mul_u32_u24 v66, 10, v65
    v_sub_u32 v66, v64, v66
    v_lshrrev_b32 v64, 4, v65
    v_mul_u32_u24 v67, 20, v64
    v_and_b32 v68, 15, v65
    v_add3_u32 v67, v67, v68, s15
    v_mul_u32_u24 v67, 1280, v67
    v_lshl_add_u32 v233, v66, 4, v67
    v_lshlrev_b32_e64 v64, 2, v64
    v_bfe_u32 v67, v65, 2, 1
    v_lshl_add_u32 v64, v67, 1, v64
    v_bfe_u32 v67, v65, 3, 1
    v_add_u32 v64, v64, v67
    v_mul_u32_u24 v64, 20, v64
    v_and_b32_e64 v67, 3, v65
    v_add3_u32 v64, v64, v67, s16
    v_add_u32_e64 v64, 16, v64
    v_mul_u32_u24 v64, 1280, v64
    v_lshl_add_u32 v238, v66, 4, v64
    v_mul_u32_u24 v67, 2560, v65
    v_lshl_add_u32 v250, v66, 4, v67
    v_subrev_u32 v233, 1024, v233
    v_subrev_u32 v238, 1024, v238
    v_add_u32 v64, 128, v1
    v_mul_u32_u24 v65, 6554, v64
    v_lshrrev_b32 v65, 16, v65
    v_mul_u32_u24 v66, 10, v65
    v_sub_u32 v66, v64, v66
    v_lshrrev_b32 v64, 4, v65
    v_mul_u32_u24 v67, 20, v64
    v_and_b32 v68, 15, v65
    v_add3_u32 v67, v67, v68, s15
    v_mul_u32_u24 v67, 1280, v67
    v_lshl_add_u32 v234, v66, 4, v67
    v_lshlrev_b32_e64 v64, 2, v64
    v_bfe_u32 v67, v65, 2, 1
    v_lshl_add_u32 v64, v67, 1, v64
    v_bfe_u32 v67, v65, 3, 1
    v_add_u32 v64, v64, v67
    v_mul_u32_u24 v64, 20, v64
    v_and_b32_e64 v67, 3, v65
    v_add3_u32 v64, v64, v67, s16
    v_add_u32_e64 v64, 16, v64
    v_mul_u32_u24 v64, 1280, v64
    v_lshl_add_u32 v239, v66, 4, v64
    v_mul_u32_u24 v67, 2560, v65
    v_lshl_add_u32 v251, v66, 4, v67
    v_subrev_u32 v234, 2048, v234
    v_subrev_u32 v239, 2048, v239
    v_add_u32 v64, 192, v1
    v_mul_u32_u24 v65, 6554, v64
    v_lshrrev_b32 v65, 16, v65
    v_mul_u32_u24 v66, 10, v65
    v_sub_u32 v66, v64, v66
    v_lshrrev_b32 v64, 4, v65
    v_mul_u32_u24 v67, 20, v64
    v_and_b32 v68, 15, v65
    v_add3_u32 v67, v67, v68, s15
    v_mul_u32_u24 v67, 1280, v67
    v_lshl_add_u32 v235, v66, 4, v67
    v_lshlrev_b32_e64 v64, 2, v64
    v_bfe_u32 v67, v65, 2, 1
    v_lshl_add_u32 v64, v67, 1, v64
    v_bfe_u32 v67, v65, 3, 1
    v_add_u32 v64, v64, v67
    v_mul_u32_u24 v64, 20, v64
    v_and_b32_e64 v67, 3, v65
    v_add3_u32 v64, v64, v67, s16
    v_add_u32_e64 v64, 16, v64
    v_mul_u32_u24 v64, 1280, v64
    v_lshl_add_u32 v240, v66, 4, v64
    v_mul_u32_u24 v67, 2560, v65
    v_lshl_add_u32 v252, v66, 4, v67
    v_subrev_u32 v235, 3072, v235
    v_subrev_u32 v240, 3072, v240
    v_add_u32 v64, 256, v1
    v_mul_u32_u24 v65, 6554, v64
    v_lshrrev_b32 v65, 16, v65
    v_mul_u32_u24 v66, 10, v65
    v_sub_u32 v66, v64, v66
    v_lshrrev_b32 v64, 4, v65
    v_mul_u32_u24 v67, 20, v64
    v_and_b32 v68, 15, v65
    v_add3_u32 v67, v67, v68, s15
    v_mul_u32_u24 v67, 1280, v67
    v_lshl_add_u32 v236, v66, 4, v67
    v_lshlrev_b32_e64 v64, 2, v64
    v_bfe_u32 v67, v65, 2, 1
    v_lshl_add_u32 v64, v67, 1, v64
    v_bfe_u32 v67, v65, 3, 1
    v_add_u32 v64, v64, v67
    v_mul_u32_u24 v64, 20, v64
    v_and_b32_e64 v67, 3, v65
    v_add3_u32 v64, v64, v67, s16
    v_add_u32_e64 v64, 16, v64
    v_mul_u32_u24 v64, 1280, v64
    v_lshl_add_u32 v241, v66, 4, v64
    v_mul_u32_u24 v67, 2560, v65
    v_lshl_add_u32 v253, v66, 4, v67
    s_mov_b32 s3, 163840
    v_lshrrev_b32 v70, 4, v1
    v_and_b32 v69, 15, v1
    v_lshrrev_b32_e64 v65, 1, v70
    v_mul_lo_u32 v244, v65, s3
    v_and_b32_e64 v66, 1, v70
    v_lshl_add_u32 v244, v66, 9, v244
    v_lshl_add_u32 v244, v69, 4, v244
    v_mul_lo_u32 v245, v70, s3
    v_lshlrev_b32_e64 v245, 1, v245
    v_lshl_add_u32 v245, v69, 3, v245
    v_add_u32_e64 v246, s3, v245
    v_bfe_u32 v67, v1, 2, 2
    v_lshl_add_u32 v67, v65, 4, v67
    v_lshl_add_u32 v67, v66, 2, v67
    v_mul_u32_u24 v242, 160, v67
    v_and_b32_e64 v68, 3, v1
    v_lshl_add_u32 v242, v68, 3, v242
    v_add_u32 v243, 61440, v242
    s_add_u32 s3, s47, 102400
    v_mul_u32_u24 v247, 160, v69
    v_lshl_add_u32 v247, v70, 3, v247
    v_add_u32 v247, s3, v247
    v_add_u32 v248, s3, v7
    v_and_b32_e64 v254, 31, v1
    v_lshlrev_b32 v254, 2, v254
    s_add_u32 s3, s14, 48
    s_mul_i32 s3, s3, 2560
    v_add_u32 v4, s3, v7
    v_add_u32 v5, s3, v8
    v_add_u32_e64 v6, s3, v9
    s_add_u32 s21, s14, 1
    s_cmp_lg_u32 s13, 0
    s_cselect_b32 s21, 9, s21
    s_mov_b32 s22, 0
    s_waitcnt vmcnt(0) lgkmcnt(0)
    s_barrier
    s_setprio 1
    s_cmp_ge_u32 s14, 4
    s_cbranch_scc1 L_pr1
    s_setprio 2
L_pr1:
L_b_start:
    ds_read_b128 v[32:35], v4 offset:20480
    ds_read_b64 v[36:37], v5 offset:20480
    ds_read_b128 v[48:51], v4 offset:17920
    ds_read_b64 v[56:57], v5 offset:17920
    s_andn2_b64 exec, s[26:27], 0x40000000
    ds_read_b128 v[40:43], v6 offset:20480
    s_mov_b64 exec, -1
    s_waitcnt lgkmcnt(3)
    v_mfma_f32_32x32x16_bf16 v[64:79], v[32:35], v[16:19], v[128:143]
    v_mfma_f32_32x32x8_bf16 v[64:79], v[36:37], v[20:21], v[64:79]
    s_waitcnt lgkmcnt(1)
    v_mfma_f32_32x32x16_bf16 v[80:95], v[48:51], v[16:19], 0
    v_mfma_f32_32x32x8_bf16 v[80:95], v[56:57], v[20:21], v[80:95]
    s_add_u32 m0, s25, 0
    s_add_u32 s3, s30, 0
    buffer_load_dwordx4 v7, s[8:11], s3 offen lds
    buffer_load_dwordx4 v7, s[8:11], s3 offen offset:1024 lds
    s_cmp_lg_u32 s22, 0
    s_cbranch_scc1 L_b_havem
    s_nop 5
    v_max3_f32 v11, v64, v65, v66
    v_max_f32_e64 v11, v11, v67
    v_max3_f32 v11, v68, v69, v11
    v_max3_f32 v11, v70, v71, v11
    v_max3_f32 v11, v72, v73, v11
    v_max3_f32 v11, v74, v75, v11
    v_max3_f32 v11, v76, v77, v11
    v_max3_f32 v11, v78, v79, v11
    s_cmp_eq_u32 s21, 1
    s_cbranch_scc1 L_b_one
    s_nop 1
    v_max3_f32 v11, v80, v81, v11
    v_max3_f32 v11, v82, v83, v11
    v_max3_f32 v11, v84, v85, v11
    v_max3_f32 v11, v86, v87, v11
    v_max3_f32 v11, v88, v89, v11
    v_max3_f32 v11, v90, v91, v11
    v_max3_f32 v11, v92, v93, v11
    v_max3_f32 v11, v94, v95, v11
L_b_one:
    v_mov_b32 v13, v11
    s_nop 1
    v_permlane32_swap_b32 v13, v11
    s_nop 1
    v_max_f32 v11, v11, v13
    v_sub_f32 v11, 0xc2200000, v11
L_b_havem:
    s_nop 7
    v_add_f32 v64, v11, v64
    v_add_f32 v65, v11, v65
    v_add_f32 v66, v11, v66
    v_add_f32 v67, v11, v67
    v_add_f32 v68, v11, v68
    v_add_f32 v69, v11, v69
    v_add_f32 v70, v11, v70
    v_add_f32 v71, v11, v71
    v_add_f32 v72, v11, v72
    v_add_f32 v73, v11, v73
    v_add_f32 v74, v11, v74
    v_add_f32 v75, v11, v75
    v_add_f32 v76, v11, v76
    v_add_f32 v77, v11, v77
    v_add_f32 v78, v11, v78
    v_add_f32 v79, v11, v79
    v_add_f32 v80, v11, v80
    v_add_f32 v81, v11, v81
    v_add_f32 v82, v11, v82
    v_add_f32 v83, v11, v83
    v_add_f32 v84, v11, v84
    v_add_f32 v85, v11, v85
    v_add_f32 v86, v11, v86
    v_add_f32 v87, v11, v87
    v_add_f32 v88, v11, v88
    v_add_f32 v89, v11, v89
    v_add_f32 v90, v11, v90
    v_add_f32 v91, v11, v91
    v_add_f32 v92, v11, v92
    v_add_f32 v93, v11, v93
    v_add_f32 v94, v11, v94
    v_add_f32 v95, v11, v95
    v_mov_b32 v112, v11
    v_add_f32 v160, v11, v144
    v_mov_b32 v113, v11
    v_add_f32 v161, v11, v145
    v_mov_b32 v114, v11
    v_add_f32 v162, v11, v146
    v_mov_b32 v115, v11
    v_add_f32 v163, v11, v147
    v_mov_b32 v116, v11
    v_add_f32 v164, v11, v148
    v_mov_b32 v117, v11
    v_add_f32 v165, v11, v149
    v_mov_b32 v118, v11
    v_add_f32 v166, v11, v150
    v_mov_b32 v119, v11
    v_add_f32 v167, v11, v151
    v_mov_b32 v120, v11
    v_add_f32 v168, v11, v152
    v_mov_b32 v121, v11
    v_add_f32 v169, v11, v153
    v_mov_b32 v122, v11
    v_add_f32 v170, v11, v154
    v_mov_b32 v123, v11
    v_add_f32 v171, v11, v155
    v_mov_b32 v124, v11
    v_add_f32 v172, v11, v156
    v_mov_b32 v125, v11
    v_add_f32 v173, v11, v157
    v_mov_b32 v126, v11
    v_add_f32 v174, v11, v158
    v_mov_b32 v127, v11
    v_add_f32 v175, v11, v159
    s_nop 0
    v_exp_f32 v56, v64
    v_exp_f32 v57, v65
    v_exp_f32_e64 v58, v66
    v_exp_f32 v59, v67
    s_waitcnt lgkmcnt(0)
    v_cvt_pk_bf16_f32 v48, v56, v57
    v_cvt_pk_bf16_f32 v49, v58, v59
    v_exp_f32 v60, v68
    v_exp_f32 v61, v69
    v_exp_f32_e64 v62, v70
    v_exp_f32 v63, v71
    s_nop 0
    ds_read_b128 v[32:35], v4 offset:15360
    ds_read_b64 v[36:37], v5 offset:15360
    v_cvt_pk_bf16_f32 v50, v60, v61
    v_cvt_pk_bf16_f32 v51, v62, v63
    v_exp_f32 v56, v72
    v_exp_f32 v57, v73
    v_exp_f32 v58, v74
    v_exp_f32 v59, v75
    v_mfma_f32_32x32x16_bf16 v[96:111], v[40:43], v[48:51], 0
    s_andn2_b64 exec, s[26:27], 0x40000000
    ds_read_b128 v[44:47], v6 offset:21120
    ds_read_b128 v[40:43], v6 offset:17920
    s_orn2_b64 exec, 0x40000000, 0
    s_add_u32 m0, s25, 2048
    s_add_u32 s3, s30, 2048
    buffer_load_dwordx4 v7, s[8:11], s3 offen lds
    buffer_load_dwordx4 v7, s[8:11], s3 offen offset:1024 lds
    v_cvt_pk_bf16_f32 v52, v56, v57
    v_cvt_pk_bf16_f32 v53, v58, v59
    v_exp_f32 v60, v76
    v_exp_f32 v61, v77
    v_exp_f32_e64 v62, v78
    v_exp_f32 v63, v79
    s_cmp_eq_u32 s21, 1
    s_cbranch_scc1 L_b_rem0
    s_waitcnt lgkmcnt(3)
    v_mfma_f32_32x32x16_bf16 v[64:79], v[32:35], v[16:19], v[112:127]
    v_cvt_pk_bf16_f32 v54, v60, v61
    v_cvt_pk_bf16_f32 v55, v62, v63
    v_exp_f32 v56, v80
    v_exp_f32 v57, v81
    v_exp_f32_e64 v58, v82
    v_exp_f32 v59, v83
    s_waitcnt lgkmcnt(0)
    v_mfma_f32_32x32x16_bf16 v[96:111], v[44:47], v[52:55], v[96:111]
    v_cvt_pk_bf16_f32 v48, v56, v57
    v_cvt_pk_bf16_f32 v49, v58, v59
    v_exp_f32 v60, v84
    v_exp_f32 v61, v85
    v_exp_f32 v62, v86
    v_exp_f32 v63, v87
    v_mfma_f32_32x32x8_bf16 v[64:79], v[36:37], v[20:21], v[64:79]
    ds_read_b128 v[32:35], v4 offset:12800
    ds_read_b64 v[36:37], v5 offset:12800
    v_cvt_pk_bf16_f32 v50, v60, v61
    v_cvt_pk_bf16_f32 v51, v62, v63
    v_exp_f32 v56, v88
    v_exp_f32 v57, v89
    v_exp_f32 v58, v90
    v_exp_f32 v59, v91
    v_mfma_f32_32x32x16_bf16 v[96:111], v[40:43], v[48:51], v[96:111]
    s_andn2_b64 exec, s[26:27], 0x40000000
    ds_read_b128 v[44:47], v6 offset:18560
    ds_read_b128 v[40:43], v6 offset:15360
    s_orn2_b64 exec, 0x40000000, 0
    s_add_u32 m0, s25, 4096
    s_add_u32 s3, s30, 4096
    buffer_load_dwordx4 v7, s[8:11], s3 offen lds
    buffer_load_dwordx4 v7, s[8:11], s3 offen offset:1024 lds
    v_cvt_pk_bf16_f32 v52, v56, v57
    v_cvt_pk_bf16_f32 v53, v58, v59
    v_exp_f32 v60, v92
    v_exp_f32 v61, v93
    v_exp_f32_e64 v62, v94
    v_exp_f32 v63, v95
    s_cmp_eq_u32 s21, 2
    s_cbranch_scc1 L_b_rem1
    s_waitcnt lgkmcnt(3)
    v_mfma_f32_32x32x16_bf16 v[80:95], v[32:35], v[16:19], v[112:127]
    v_cvt_pk_bf16_f32 v54, v60, v61
    v_cvt_pk_bf16_f32 v55, v62, v63
    v_exp_f32 v56, v64
    v_exp_f32 v57, v65
    v_exp_f32_e64 v58, v66
    v_exp_f32 v59, v67
    s_waitcnt lgkmcnt(0)
    v_mfma_f32_32x32x16_bf16 v[96:111], v[44:47], v[52:55], v[96:111]
    v_cvt_pk_bf16_f32 v48, v56, v57
    v_cvt_pk_bf16_f32 v49, v58, v59
    v_exp_f32 v60, v68
    v_exp_f32 v61, v69
    v_exp_f32 v62, v70
    v_exp_f32 v63, v71
    v_mfma_f32_32x32x8_bf16 v[80:95], v[36:37], v[20:21], v[80:95]
    ds_read_b128 v[32:35], v4 offset:10240
    ds_read_b64 v[36:37], v5 offset:10240
    v_cvt_pk_bf16_f32 v50, v60, v61
    v_cvt_pk_bf16_f32 v51, v62, v63
    v_exp_f32 v56, v72
    v_exp_f32 v57, v73
    v_exp_f32 v58, v74
    v_exp_f32 v59, v75
    v_mfma_f32_32x32x16_bf16 v[96:111], v[40:43], v[48:51], v[96:111]
    s_andn2_b64 exec, s[26:27], 0x40000000
    ds_read_b128 v[44:47], v6 offset:16000
    ds_read_b128 v[40:43], v6 offset:12800
    s_orn2_b64 exec, 0x40000000, 0
    s_add_u32 m0, s25, 6144
    s_add_u32 s3, s30, 6144
    buffer_load_dwordx4 v7, s[8:11], s3 offen lds
    buffer_load_dwordx4 v7, s[8:11], s3 offen offset:1024 lds
    v_cvt_pk_bf16_f32 v52, v56, v57
    v_cvt_pk_bf16_f32 v53, v58, v59
    v_exp_f32 v60, v76
    v_exp_f32 v61, v77
    v_exp_f32_e64 v62, v78
    v_exp_f32 v63, v79
    s_cmp_eq_u32 s21, 3
    s_cbranch_scc1 L_b_rem2
    s_waitcnt lgkmcnt(3)
    v_mfma_f32_32x32x16_bf16 v[64:79], v[32:35], v[16:19], v[112:127]
    v_cvt_pk_bf16_f32 v54, v60, v61
    v_cvt_pk_bf16_f32 v55, v62, v63
    v_exp_f32 v56, v80
    v_exp_f32 v57, v81
    v_exp_f32_e64 v58, v82
    v_exp_f32 v59, v83
    s_waitcnt lgkmcnt(0)
    v_mfma_f32_32x32x16_bf16 v[96:111], v[44:47], v[52:55], v[96:111]
    v_cvt_pk_bf16_f32 v48, v56, v57
    v_cvt_pk_bf16_f32 v49, v58, v59
    v_exp_f32 v60, v84
    v_exp_f32 v61, v85
    v_exp_f32 v62, v86
    v_exp_f32 v63, v87
    v_mfma_f32_32x32x8_bf16 v[64:79], v[36:37], v[20:21], v[64:79]
    ds_read_b128 v[32:35], v4 offset:7680
    ds_read_b64 v[36:37], v5 offset:7680
    v_cvt_pk_bf16_f32 v50, v60, v61
    v_cvt_pk_bf16_f32 v51, v62, v63
    v_exp_f32 v56, v88
    v_exp_f32 v57, v89
    v_exp_f32 v58, v90
    v_exp_f32 v59, v91
    v_mfma_f32_32x32x16_bf16 v[96:111], v[40:43], v[48:51], v[96:111]
    s_andn2_b64 exec, s[26:27], 0x40000000
    ds_read_b128 v[44:47], v6 offset:13440
    ds_read_b128 v[40:43], v6 offset:10240
    s_orn2_b64 exec, 0x40000000, 0
    s_add_u32 m0, s25, 8192
    s_add_u32 s3, s30, 8192
    buffer_load_dwordx4 v7, s[8:11], s3 offen lds
    buffer_load_dwordx4 v7, s[8:11], s3 offen offset:1024 lds
    v_cvt_pk_bf16_f32 v52, v56, v57
    v_cvt_pk_bf16_f32 v53, v58, v59
    v_exp_f32 v60, v92
    v_exp_f32 v61, v93
    v_exp_f32_e64 v62, v94
    v_exp_f32 v63, v95
    s_cmp_eq_u32 s21, 4
    s_cbranch_scc1 L_b_rem3
    s_waitcnt lgkmcnt(3)
    v_mfma_f32_32x32x16_bf16 v[80:95], v[32:35], v[16:19], v[112:127]
    v_cvt_pk_bf16_f32 v54, v60, v61
    v_cvt_pk_bf16_f32 v55, v62, v63
    v_exp_f32 v56, v64
    v_exp_f32 v57, v65
    v_exp_f32_e64 v58, v66
    v_exp_f32 v59, v67
    s_waitcnt lgkmcnt(0)
    v_mfma_f32_32x32x16_bf16 v[96:111], v[44:47], v[52:55], v[96:111]
    v_cvt_pk_bf16_f32 v48, v56, v57
    v_cvt_pk_bf16_f32 v49, v58, v59
    v_exp_f32 v60, v68
    v_exp_f32 v61, v69
    v_exp_f32 v62, v70
    v_exp_f32 v63, v71
    v_mfma_f32_32x32x8_bf16 v[80:95], v[36:37], v[20:21], v[80:95]
    ds_read_b128 v[32:35], v4 offset:5120
    ds_read_b64 v[36:37], v5 offset:5120
    v_cvt_pk_bf16_f32 v50, v60, v61
    v_cvt_pk_bf16_f32 v51, v62, v63
    v_exp_f32 v56, v72
    v_exp_f32 v57, v73
    v_exp_f32 v58, v74
    v_exp_f32 v59, v75
    v_mfma_f32_32x32x16_bf16 v[96:111], v[40:43], v[48:51], v[96:111]
    s_andn2_b64 exec, s[26:27], 0x40000000
    ds_read_b128 v[44:47], v6 offset:10880
    ds_read_b128 v[40:43], v6 offset:7680
    s_orn2_b64 exec, 0x40000000, 0
    s_add_u32 m0, s25, 10240
    s_add_u32 s3, s30, 10240
    buffer_load_dwordx4 v7, s[8:11], s3 offen lds
    buffer_load_dwordx4 v7, s[8:11], s3 offen offset:1024 lds
    v_cvt_pk_bf16_f32 v52, v56, v57
    v_cvt_pk_bf16_f32 v53, v58, v59
    v_exp_f32 v60, v76
    v_exp_f32 v61, v77
    v_exp_f32_e64 v62, v78
    v_exp_f32 v63, v79
    s_cmp_eq_u32 s21, 5
    s_cbranch_scc1 L_b_rem4
    s_waitcnt lgkmcnt(3)
    v_mfma_f32_32x32x16_bf16 v[64:79], v[32:35], v[16:19], v[112:127]
    v_cvt_pk_bf16_f32 v54, v60, v61
    v_cvt_pk_bf16_f32 v55, v62, v63
    v_exp_f32 v56, v80
    v_exp_f32 v57, v81
    v_exp_f32_e64 v58, v82
    v_exp_f32 v59, v83
    s_waitcnt lgkmcnt(0)
    v_mfma_f32_32x32x16_bf16 v[96:111], v[44:47], v[52:55], v[96:111]
    v_cvt_pk_bf16_f32 v48, v56, v57
    v_cvt_pk_bf16_f32 v49, v58, v59
    v_exp_f32 v60, v84
    v_exp_f32 v61, v85
    v_exp_f32 v62, v86
    v_exp_f32 v63, v87
    v_mfma_f32_32x32x8_bf16 v[64:79], v[36:37], v[20:21], v[64:79]
    ds_read_b128 v[32:35], v4 offset:2560
    ds_read_b64 v[36:37], v5 offset:2560
    v_cvt_pk_bf16_f32 v50, v60, v61
    v_cvt_pk_bf16_f32 v51, v62, v63
    v_exp_f32 v56, v88
    v_exp_f32 v57, v89
    v_exp_f32 v58, v90
    v_exp_f32 v59, v91
    v_mfma_f32_32x32x16_bf16 v[96:111], v[40:43], v[48:51], v[96:111]
    s_andn2_b64 exec, s[26:27], 0x40000000
    ds_read_b128 v[44:47], v6 offset:8320
    ds_read_b128 v[40:43], v6 offset:5120
    s_orn2_b64 exec, 0x40000000, 0
    s_add_u32 m0, s25, 12288
    s_add_u32 s3, s30, 12288
    buffer_load_dwordx4 v7, s[8:11], s3 offen lds
    buffer_load_dwordx4 v7, s[8:11], s3 offen offset:1024 lds
    v_cvt_pk_bf16_f32 v52, v56, v57
    v_cvt_pk_bf16_f32 v53, v58, v59
    v_exp_f32 v60, v92
    v_exp_f32 v61, v93
    v_exp_f32 v62, v94
    v_exp_f32 v63, v95
    s_cmp_eq_u32 s21, 6
    s_cbranch_scc1 L_b_rem5
    s_cmp_ge_u32 s14, 4
    s_cbranch_scc1 L_pr2
    s_setprio 0
L_pr2:
    s_waitcnt lgkmcnt(3)
    v_mfma_f32_32x32x16_bf16 v[80:95], v[32:35], v[16:19], v[112:127]
    v_cvt_pk_bf16_f32 v54, v60, v61
    v_cvt_pk_bf16_f32 v55, v62, v63
    v_exp_f32 v56, v64
    v_exp_f32 v57, v65
    v_exp_f32_e64 v58, v66
    v_exp_f32 v59, v67
    s_waitcnt lgkmcnt(0)
    v_mfma_f32_32x32x16_bf16 v[96:111], v[44:47], v[52:55], v[96:111]
    v_cvt_pk_bf16_f32 v48, v56, v57
    v_cvt_pk_bf16_f32 v49, v58, v59
    v_exp_f32 v60, v68
    v_exp_f32 v61, v69
    v_exp_f32 v62, v70
    v_exp_f32 v63, v71
    v_mfma_f32_32x32x8_bf16 v[80:95], v[36:37], v[20:21], v[80:95]
    ds_read_b128 v[32:35], v4 offset:0
    ds_read_b64 v[36:37], v5 offset:0
    v_cvt_pk_bf16_f32 v50, v60, v61
    v_cvt_pk_bf16_f32 v51, v62, v63
    v_exp_f32 v56, v72
    v_exp_f32 v57, v73
    v_exp_f32 v58, v74
    v_exp_f32 v59, v75
    v_mfma_f32_32x32x16_bf16 v[96:111], v[40:43], v[48:51], v[96:111]
    s_andn2_b64 exec, s[26:27], 0x40000000
    ds_read_b128 v[44:47], v6 offset:5760
    ds_read_b128 v[40:43], v6 offset:2560
    s_orn2_b64 exec, 0x40000000, 0
    s_add_u32 m0, s25, 14336
    s_add_u32 s3, s30, 14336
    buffer_load_dwordx4 v7, s[8:11], s3 offen lds
    buffer_load_dwordx4 v[24:27], v7, s[8:11], s19 offen
    s_mov_b64 exec, s[28:29]
    buffer_load_dwordx2 v[28:29], v8, s[8:11], s19 offen
    s_mov_b64 exec, -1
    v_cvt_pk_bf16_f32 v52, v56, v57
    v_cvt_pk_bf16_f32 v53, v58, v59
    v_exp_f32 v60, v76
    v_exp_f32 v61, v77
    v_exp_f32_e64 v62, v78
    v_exp_f32 v63, v79
    s_cmp_eq_u32 s21, 7
    s_cbranch_scc1 L_b_rem6
    s_waitcnt lgkmcnt(3)
    v_mfma_f32_32x32x16_bf16 v[64:79], v[32:35], v[16:19], v[160:175]
    v_cvt_pk_bf16_f32 v54, v60, v61
    v_cvt_pk_bf16_f32 v55, v62, v63
    v_exp_f32 v56, v80
    v_exp_f32 v57, v81
    v_exp_f32_e64 v58, v82
    v_exp_f32 v59, v83
    s_waitcnt lgkmcnt(0)
    v_mfma_f32_32x32x16_bf16 v[96:111], v[44:47], v[52:55], v[96:111]
    v_cvt_pk_bf16_f32 v48, v56, v57
    v_cvt_pk_bf16_f32 v49, v58, v59
    v_exp_f32 v60, v84
    v_exp_f32 v61, v85
    v_exp_f32 v62, v86
    v_exp_f32 v63, v87
    v_mfma_f32_32x32x8_bf16 v[64:79], v[36:37], v[20:21], v[64:79]
    v_cvt_pk_bf16_f32 v50, v60, v61
    v_cvt_pk_bf16_f32 v51, v62, v63
    v_exp_f32 v56, v88
    v_exp_f32 v57, v89
    v_exp_f32 v58, v90
    v_exp_f32 v59, v91
    v_mfma_f32_32x32x16_bf16 v[96:111], v[40:43], v[48:51], v[96:111]
    s_andn2_b64 exec, s[26:27], 0x40000000
    ds_read_b128 v[44:47], v6 offset:3200
    ds_read_b128 v[40:43], v6 offset:0
    s_orn2_b64 exec, 0x40000000, 0
    v_cvt_pk_bf16_f32 v52, v56, v57
    v_cvt_pk_bf16_f32 v53, v58, v59
    v_exp_f32 v60, v92
    v_exp_f32 v61, v93
    v_exp_f32_e64 v62, v94
    v_exp_f32 v63, v95
    s_cmp_eq_u32 s21, 8
    s_cbranch_scc1 L_b_rem7
    s_nop 0
    v_cvt_pk_bf16_f32 v54, v60, v61
    v_cvt_pk_bf16_f32 v55, v62, v63
    v_exp_f32 v56, v64
    v_exp_f32 v57, v65
    v_exp_f32_e64 v58, v66
    v_exp_f32 v59, v67
    s_waitcnt lgkmcnt(0)
    v_mfma_f32_32x32x16_bf16 v[96:111], v[44:47], v[52:55], v[96:111]
    v_cvt_pk_bf16_f32 v48, v56, v57
    v_cvt_pk_bf16_f32 v49, v58, v59
    v_exp_f32 v60, v68
    v_exp_f32 v61, v69
    v_exp_f32_e64 v62, v70
    v_exp_f32 v63, v71
    s_nop 0
    v_cvt_pk_bf16_f32 v50, v60, v61
    v_cvt_pk_bf16_f32 v51, v62, v63
    v_exp_f32 v56, v72
    v_exp_f32 v57, v73
    v_exp_f32 v58, v74
    v_exp_f32 v59, v75
    v_mfma_f32_32x32x16_bf16 v[96:111], v[40:43], v[48:51], v[96:111]
    s_andn2_b64 exec, s[26:27], 0x40000000
    ds_read_b128 v[44:47], v6 offset:640
    s_orn2_b64 exec, 0x40000000, 0
    v_cvt_pk_bf16_f32 v52, v56, v57
    v_cvt_pk_bf16_f32 v53, v58, v59
    v_exp_f32 v60, v76
    v_exp_f32 v61, v77
    v_exp_f32_e64 v62, v78
    v_exp_f32 v63, v79
L_b_rem6:
L_b_rem7:
    s_nop 0
    v_cvt_pk_bf16_f32 v54, v60, v61
    v_cvt_pk_bf16_f32 v55, v62, v63
    s_waitcnt lgkmcnt(0)
    s_nop 0
    v_mfma_f32_32x32x16_bf16 v[96:111], v[44:47], v[52:55], v[96:111]
L_b_fin:
    s_nop 15
    s_mov_b32 s3, 0x71800000
    v_cmp_gt_f32 vcc, s3, v108
    s_mov_b32 s3, 0xd800000
    v_cmp_lt_f32 s[6:7], s3, v108
    v_rcp_f32 v13, v108
    s_and_b64 vcc, vcc, s[6:7]
    s_cmp_eq_u64 vcc, -1
    s_cbranch_scc1 L_b_ok
    s_cmp_eq_u32 s22, 0
    s_cbranch_scc1 L_b_exact
L_b_ok:
    v_mul_f32 v96, v96, v13
    v_mul_f32 v97, v97, v13
    v_mul_f32 v98, v98, v13
    v_mul_f32 v99, v99, v13
    v_mul_f32 v100, v100, v13
    v_mul_f32 v101, v101, v13
    v_mul_f32 v102, v102, v13
    v_mul_f32 v103, v103, v13
    v_mul_f32 v104, v104, v13
    v_mul_f32 v105, v105, v13
    v_mul_f32 v106, v106, v13
    v_mul_f32 v107, v107, v13
    v_cvt_pk_bf16_f32 v56, v96, v97
    v_cvt_pk_bf16_f32 v57, v98, v99
    v_cvt_pk_bf16_f32 v58, v100, v101
    v_cvt_pk_bf16_f32 v59, v102, v103
    v_cvt_pk_bf16_f32 v60, v104, v105
    v_cvt_pk_bf16_f32 v61, v106, v107
    buffer_store_dwordx4 v[56:59], v7, s[8:11], s20 offen offset:1280 sc1
    s_mov_b64 exec, s[28:29]
    buffer_store_dwordx2 v[60:61], v10, s[8:11], s20 offen offset:2304 sc1
    s_mov_b64 exec, -1
    s_waitcnt vmcnt(2)
    s_barrier
    s_add_u32 m0, s24, 122880
    s_add_u32 s3, s17, 122880
    buffer_load_dwordx4 v2, s[8:11], s3 offen offset:0 lds
    buffer_load_dwordx4 v2, s[8:11], s3 offen offset:1024 lds
    buffer_load_dwordx4 v2, s[8:11], s3 offen offset:2048 lds
    buffer_load_dwordx4 v2, s[8:11], s3 offen offset:3072 lds
    s_add_u32 m0, s24, 126976
    s_nop 0
    buffer_load_dwordx4 v3, s[8:11], s3 offen lds
    v_mov_b32 v16, v24
    v_mov_b32 v17, v25
    v_mov_b32 v18, v26
    v_mov_b32 v19, v27
    v_mov_b32 v20, v28
    v_mov_b32 v21, v29
    s_mov_b32 s22, 0
L_a_start:
    v_mov_b32 v4, v7
    v_mov_b32 v5, v8
    v_mov_b32_e64 v6, v9
    ds_read_b128 v[48:51], v4 offset:0
    ds_read_b64 v[56:57], v5 offset:0
    ds_read_b128 v[32:35], v4 offset:2560
    ds_read_b64 v[36:37], v5 offset:2560
    s_andn2_b64 exec, s[26:27], 0x40000000
    ds_read_b128 v[40:43], v6
    ds_read_b128 v[40:43], v6
    s_mov_b64 exec, -1
    s_waitcnt lgkmcnt(4)
    v_mfma_f32_32x32x16_bf16 v[64:79], v[48:51], v[16:19], 0
    v_mfma_f32_32x32x8_bf16 v[64:79], v[56:57], v[20:21], v[64:79]
    v_mov_b32 v96, 0
    v_mov_b32 v97, 0
    v_mov_b32 v98, 0
    v_mov_b32 v99, 0
    v_mov_b32 v100, 0
    v_mov_b32 v101, 0
    v_mov_b32 v102, 0
    v_mov_b32 v103, 0
    v_mov_b32 v104, 0
    v_mov_b32 v105, 0
    v_mov_b32 v106, 0
    v_mov_b32 v107, 0
    v_mov_b32 v108, 0
    v_mov_b32 v109, 0
    v_mov_b32 v110, 0
    v_mov_b32 v111, 0
    v_mov_b32 v60, 0
    v_mov_b32 v61, 0
    v_mov_b32 v62, 0
    v_mov_b32 v63, 0
    v_mov_b32 v52, 0
    v_mov_b32 v53, 0
    s_mov_b32 s23, 0
    s_nop 1
    v_max3_f32 v11, v64, v65, v66
    v_max_f32_e64 v11, v11, v67
    v_max3_f32 v11, v68, v69, v11
    v_max3_f32 v11, v70, v71, v11
    v_max3_f32 v11, v72, v73, v11
    v_max3_f32 v11, v74, v75, v11
    v_max3_f32 v11, v76, v77, v11
    v_max3_f32 v11, v78, v79, v11
    v_mov_b32 v13, v11
    s_nop 1
    v_permlane32_swap_b32 v13, v11
    s_nop 1
    v_max_f32_e64 v11, v11, v13
    v_sub_f32 v11, 0xc2200000, v11
    v_mov_b32 v112, v11
    v_mov_b32 v113, v11
    v_mov_b32 v114, v11
    v_mov_b32 v115, v11
    v_mov_b32 v116, v11
    v_mov_b32 v117, v11
    v_mov_b32 v118, v11
    v_mov_b32 v119, v11
    v_mov_b32 v120, v11
    v_mov_b32 v121, v11
    v_mov_b32 v122, v11
    v_mov_b32 v123, v11
    v_mov_b32 v124, v11
    v_mov_b32 v125, v11
    v_mov_b32 v126, v11
    v_mov_b32 v127, v11
    v_add_f32 v64, v11, v64
    v_add_f32 v65, v11, v65
    v_add_f32 v66, v11, v66
    v_add_f32 v67, v11, v67
    v_add_f32 v68, v11, v68
    v_add_f32 v69, v11, v69
    v_add_f32 v70, v11, v70
    v_add_f32 v71, v11, v71
    v_add_f32 v72, v11, v72
    v_add_f32 v73, v11, v73
    v_add_f32 v74, v11, v74
    v_add_f32 v75, v11, v75
    v_add_f32 v76, v11, v76
    v_add_f32 v77, v11, v77
    v_add_f32 v78, v11, v78
    v_add_f32 v79, v11, v79
L_a_loop:
    s_cmp_lt_u32 s23, 5
    s_cbranch_scc1 L_a_nobar
    s_cmp_lg_u32 s23, 5
    s_cbranch_scc1 L_a_wo
    s_waitcnt vmcnt(0)
    s_barrier
    s_cmp_lg_u32 s14, 4
    s_cbranch_scc1 L_sig_b
    s_mov_b64 exec, 1
    v_mov_b32 v13, 0
    v_mov_b32_e64 v14, 1
    buffer_store_dword v14, v13, s[8:11], s45 offen offset:1024 sc1
    s_orn2_b64 exec, 0x40000000, 0
L_sig_b:
L_a_wo:
    s_lshl_b32 s3, s23, 1
    s_lshr_b32 s6, s14, 2
    s_add_u32 s3, s3, s6
    s_sub_u32 s3, s3, 10
    s_cmp_gt_u32 s3, 4
    s_cbranch_scc1 L_a_nobar
    s_mul_i32 s6, s3, 20480
    s_add_u32 s6, s6, s47
    s_mov_b32 m0, s6
    s_cmp_lg_u32 s3, 4
    s_cbranch_scc1 L_a_wo1
    s_mov_b32 s3, 0
    v_mov_b32 v232, v237
    v_mov_b32 v233, v238
    v_mov_b32 v234, v239
    v_mov_b32 v235, v240
    v_mov_b32 v236, v241
L_a_wo1:
    s_mul_i32 s3, s3, 204800
    s_add_u32 s3, s3, s43
    buffer_load_dwordx4 v232, s[32:35], s3 offen offset:0 lds
    buffer_load_dwordx4 v233, s[32:35], s3 offen offset:1024 lds
    buffer_load_dwordx4 v234, s[32:35], s3 offen offset:2048 lds
    buffer_load_dwordx4 v235, s[32:35], s3 offen offset:3072 lds
    s_add_u32 m0, s6, 4096
    s_nop 0
    buffer_load_dwordx4 v236, s[32:35], s3 offen lds
L_a_nobar:
    s_cmp_ge_u32 s14, 4
    s_cbranch_scc1 L_pr3
    s_setprio 2
L_pr3:
    s_waitcnt lgkmcnt(3)
    v_mfma_f32_32x32x16_bf16 v[80:95], v[32:35], v[16:19], v[112:127]
    v_cvt_pk_bf16_f32 v54, v60, v61
    v_cvt_pk_bf16_f32 v55, v62, v63
    v_exp_f32 v56, v64
    v_exp_f32 v57, v65
    v_exp_f32_e64 v58, v66
    v_exp_f32 v59, v67
    s_waitcnt lgkmcnt(0)
    v_mfma_f32_32x32x16_bf16 v[96:111], v[44:47], v[52:55], v[96:111]
    v_cvt_pk_bf16_f32 v48, v56, v57
    v_cvt_pk_bf16_f32 v49, v58, v59
    v_exp_f32 v60, v68
    v_exp_f32 v61, v69
    v_exp_f32 v62, v70
    v_exp_f32 v63, v71
    v_mfma_f32_32x32x8_bf16 v[80:95], v[36:37], v[20:21], v[80:95]
    ds_read_b128 v[32:35], v4 offset:5120
    ds_read_b64 v[36:37], v5 offset:5120
    v_cvt_pk_bf16_f32 v50, v60, v61
    v_cvt_pk_bf16_f32 v51, v62, v63
    v_exp_f32 v56, v72
    v_exp_f32 v57, v73
    v_exp_f32 v58, v74
    v_exp_f32 v59, v75
    v_mfma_f32_32x32x16_bf16 v[96:111], v[40:43], v[48:51], v[96:111]
    s_andn2_b64 exec, s[26:27], 0x40000000
    ds_read_b128 v[44:47], v6 offset:640
    ds_read_b128 v[40:43], v6 offset:2560
    s_orn2_b64 exec, 0x40000000, 0
    v_cvt_pk_bf16_f32 v52, v56, v57
    v_cvt_pk_bf16_f32 v53, v58, v59
    v_exp_f32 v60, v76
    v_exp_f32 v61, v77
    v_exp_f32_e64 v62, v78
    v_exp_f32 v63, v79
    s_waitcnt lgkmcnt(3)
    v_mfma_f32_32x32x16_bf16 v[64:79], v[32:35], v[16:19], v[112:127]
    v_cvt_pk_bf16_f32 v54, v60, v61
    v_cvt_pk_bf16_f32 v55, v62, v63
    v_exp_f32 v56, v80
    v_exp_f32 v57, v81
    v_exp_f32_e64 v58, v82
    v_exp_f32 v59, v83
    s_waitcnt lgkmcnt(0)
    v_mfma_f32_32x32x16_bf16 v[96:111], v[44:47], v[52:55], v[96:111]
    v_cvt_pk_bf16_f32 v48, v56, v57
    v_cvt_pk_bf16_f32 v49, v58, v59
    v_exp_f32 v60, v84
    v_exp_f32 v61, v85
    v_exp_f32 v62, v86
    v_exp_f32 v63, v87
    v_mfma_f32_32x32x8_bf16 v[64:79], v[36:37], v[20:21], v[64:79]
    ds_read_b128 v[32:35], v4 offset:7680
    ds_read_b64 v[36:37], v5 offset:7680
    v_cvt_pk_bf16_f32 v50, v60, v61
    v_cvt_pk_bf16_f32 v51, v62, v63
    v_exp_f32 v56, v88
    v_exp_f32 v57, v89
    v_exp_f32 v58, v90
    v_exp_f32 v59, v91
    v_mfma_f32_32x32x16_bf16 v[96:111], v[40:43], v[48:51], v[96:111]
    s_andn2_b64 exec, s[26:27], 0x40000000
    ds_read_b128 v[44:47], v6 offset:3200
    ds_read_b128 v[40:43], v6 offset:5120
    s_orn2_b64 exec, 0x40000000, 0
    v_cvt_pk_bf16_f32 v52, v56, v57
    v_cvt_pk_bf16_f32 v53, v58, v59
    v_exp_f32 v60, v92
    v_exp_f32 v61, v93
    v_exp_f32_e64 v62, v94
    v_exp_f32 v63, v95
    s_waitcnt lgkmcnt(3)
    v_mfma_f32_32x32x16_bf16 v[80:95], v[32:35], v[16:19], v[112:127]
    v_cvt_pk_bf16_f32 v54, v60, v61
    v_cvt_pk_bf16_f32 v55, v62, v63
    v_exp_f32 v56, v64
    v_exp_f32 v57, v65
    v_exp_f32_e64 v58, v66
    v_exp_f32 v59, v67
    s_waitcnt lgkmcnt(0)
    v_mfma_f32_32x32x16_bf16 v[96:111], v[44:47], v[52:55], v[96:111]
    v_cvt_pk_bf16_f32 v48, v56, v57
    v_cvt_pk_bf16_f32 v49, v58, v59
    v_exp_f32 v60, v68
    v_exp_f32 v61, v69
    v_exp_f32 v62, v70
    v_exp_f32 v63, v71
    v_mfma_f32_32x32x8_bf16 v[80:95], v[36:37], v[20:21], v[80:95]
    ds_read_b128 v[32:35], v4 offset:10240
    ds_read_b64 v[36:37], v5 offset:10240
    v_cvt_pk_bf16_f32 v50, v60, v61
    v_cvt_pk_bf16_f32 v51, v62, v63
    v_exp_f32 v56, v72
    v_exp_f32 v57, v73
    v_exp_f32 v58, v74
    v_exp_f32 v59, v75
    v_mfma_f32_32x32x16_bf16 v[96:111], v[40:43], v[48:51], v[96:111]
    s_andn2_b64 exec, s[26:27], 0x40000000
    ds_read_b128 v[44:47], v6 offset:5760
    ds_read_b128 v[40:43], v6 offset:7680
    s_orn2_b64 exec, 0x40000000, 0
    v_cvt_pk_bf16_f32 v52, v56, v57
    v_cvt_pk_bf16_f32 v53, v58, v59
    v_exp_f32 v60, v76
    v_exp_f32 v61, v77
    v_exp_f32_e64 v62, v78
    v_exp_f32 v63, v79
    s_waitcnt lgkmcnt(3)
    v_mfma_f32_32x32x16_bf16 v[64:79], v[32:35], v[16:19], v[112:127]
    v_cvt_pk_bf16_f32 v54, v60, v61
    v_cvt_pk_bf16_f32 v55, v62, v63
    v_exp_f32 v56, v80
    v_exp_f32 v57, v81
    v_exp_f32_e64 v58, v82
    v_exp_f32 v59, v83
    s_waitcnt lgkmcnt(0)
    v_mfma_f32_32x32x16_bf16 v[96:111], v[44:47], v[52:55], v[96:111]
    v_cvt_pk_bf16_f32 v48, v56, v57
    v_cvt_pk_bf16_f32 v49, v58, v59
    v_exp_f32 v60, v84
    v_exp_f32 v61, v85
    v_exp_f32 v62, v86
    v_exp_f32 v63, v87
    v_mfma_f32_32x32x8_bf16 v[64:79], v[36:37], v[20:21], v[64:79]
    ds_read_b128 v[32:35], v4 offset:12800
    ds_read_b64 v[36:37], v5 offset:12800
    v_cvt_pk_bf16_f32 v50, v60, v61
    v_cvt_pk_bf16_f32 v51, v62, v63
    v_exp_f32 v56, v88
    v_exp_f32 v57, v89
    v_exp_f32 v58, v90
    v_exp_f32 v59, v91
    v_mfma_f32_32x32x16_bf16 v[96:111], v[40:43], v[48:51], v[96:111]
    s_andn2_b64 exec, s[26:27], 0x40000000
    ds_read_b128 v[44:47], v6 offset:8320
    ds_read_b128 v[40:43], v6 offset:10240
    s_orn2_b64 exec, 0x40000000, 0
    v_cvt_pk_bf16_f32 v52, v56, v57
    v_cvt_pk_bf16_f32 v53, v58, v59
    v_exp_f32 v60, v92
    v_exp_f32 v61, v93
    v_exp_f32_e64 v62, v94
    v_exp_f32 v63, v95
    s_waitcnt lgkmcnt(3)
    v_mfma_f32_32x32x16_bf16 v[80:95], v[32:35], v[16:19], v[112:127]
    v_cvt_pk_bf16_f32 v54, v60, v61
    v_cvt_pk_bf16_f32 v55, v62, v63
    v_exp_f32 v56, v64
    v_exp_f32 v57, v65
    v_exp_f32_e64 v58, v66
    v_exp_f32 v59, v67
    s_waitcnt lgkmcnt(0)
    v_mfma_f32_32x32x16_bf16 v[96:111], v[44:47], v[52:55], v[96:111]
    v_cvt_pk_bf16_f32 v48, v56, v57
    v_cvt_pk_bf16_f32 v49, v58, v59
    v_exp_f32 v60, v68
    v_exp_f32 v61, v69
    v_exp_f32 v62, v70
    v_exp_f32 v63, v71
    v_mfma_f32_32x32x8_bf16 v[80:95], v[36:37], v[20:21], v[80:95]
    ds_read_b128 v[32:35], v4 offset:15360
    ds_read_b64 v[36:37], v5 offset:15360
    v_cvt_pk_bf16_f32 v50, v60, v61
    v_cvt_pk_bf16_f32 v51, v62, v63
    v_exp_f32 v56, v72
    v_exp_f32 v57, v73
    v_exp_f32 v58, v74
    v_exp_f32 v59, v75
    v_mfma_f32_32x32x16_bf16 v[96:111], v[40:43], v[48:51], v[96:111]
    s_andn2_b64 exec, s[26:27], 0x40000000
    ds_read_b128 v[44:47], v6 offset:10880
    ds_read_b128 v[40:43], v6 offset:12800
    s_orn2_b64 exec, 0x40000000, 0
    v_cvt_pk_bf16_f32 v52, v56, v57
    v_cvt_pk_bf16_f32 v53, v58, v59
    v_exp_f32 v60, v76
    v_exp_f32 v61, v77
    v_exp_f32_e64 v62, v78
    v_exp_f32 v63, v79
    s_waitcnt lgkmcnt(3)
    v_mfma_f32_32x32x16_bf16 v[64:79], v[32:35], v[16:19], v[112:127]
    v_cvt_pk_bf16_f32 v54, v60, v61
    v_cvt_pk_bf16_f32 v55, v62, v63
    v_exp_f32 v56, v80
    v_exp_f32 v57, v81
    v_exp_f32_e64 v58, v82
    v_exp_f32 v59, v83
    s_waitcnt lgkmcnt(0)
    v_mfma_f32_32x32x16_bf16 v[96:111], v[44:47], v[52:55], v[96:111]
    v_cvt_pk_bf16_f32 v48, v56, v57
    v_cvt_pk_bf16_f32 v49, v58, v59
    v_exp_f32 v60, v84
    v_exp_f32 v61, v85
    v_exp_f32 v62, v86
    v_exp_f32 v63, v87
    v_mfma_f32_32x32x8_bf16 v[64:79], v[36:37], v[20:21], v[64:79]
    ds_read_b128 v[32:35], v4 offset:17920
    ds_read_b64 v[36:37], v5 offset:17920
    v_cvt_pk_bf16_f32 v50, v60, v61
    v_cvt_pk_bf16_f32 v51, v62, v63
    v_exp_f32 v56, v88
    v_exp_f32 v57, v89
    v_exp_f32 v58, v90
    v_exp_f32 v59, v91
    v_mfma_f32_32x32x16_bf16 v[96:111], v[40:43], v[48:51], v[96:111]
    s_andn2_b64 exec, s[26:27], 0x40000000
    ds_read_b128 v[44:47], v6 offset:13440
    ds_read_b128 v[40:43], v6 offset:15360
    s_orn2_b64 exec, 0x40000000, 0
    v_cvt_pk_bf16_f32 v52, v56, v57
    v_cvt_pk_bf16_f32 v53, v58, v59
    v_exp_f32 v60, v92
    v_exp_f32 v61, v93
    v_exp_f32 v62, v94
    v_exp_f32 v63, v95
    s_cmp_ge_u32 s14, 4
    s_cbranch_scc1 L_pr4
    s_setprio 0
L_pr4:
    s_waitcnt lgkmcnt(3)
    v_mfma_f32_32x32x16_bf16 v[80:95], v[32:35], v[16:19], v[112:127]
    v_cvt_pk_bf16_f32 v54, v60, v61
    v_cvt_pk_bf16_f32 v55, v62, v63
    v_exp_f32 v56, v64
    v_exp_f32 v57, v65
    v_exp_f32_e64 v58, v66
    v_exp_f32 v59, v67
    s_waitcnt lgkmcnt(0)
    v_mfma_f32_32x32x16_bf16 v[96:111], v[44:47], v[52:55], v[96:111]
    v_cvt_pk_bf16_f32 v48, v56, v57
    v_cvt_pk_bf16_f32 v49, v58, v59
    v_exp_f32 v60, v68
    v_exp_f32 v61, v69
    v_exp_f32 v62, v70
    v_exp_f32 v63, v71
    v_mfma_f32_32x32x8_bf16 v[80:95], v[36:37], v[20:21], v[80:95]
    ds_read_b128 v[32:35], v4 offset:20480
    ds_read_b64 v[36:37], v5 offset:20480
    v_cvt_pk_bf16_f32 v50, v60, v61
    v_cvt_pk_bf16_f32 v51, v62, v63
    v_exp_f32 v56, v72
    v_exp_f32 v57, v73
    v_exp_f32 v58, v74
    v_exp_f32 v59, v75
    v_mfma_f32_32x32x16_bf16 v[96:111], v[40:43], v[48:51], v[96:111]
    s_andn2_b64 exec, s[26:27], 0x40000000
    ds_read_b128 v[44:47], v6 offset:16000
    ds_read_b128 v[40:43], v6 offset:17920
    s_orn2_b64 exec, 0x40000000, 0
    v_cvt_pk_bf16_f32 v52, v56, v57
    v_cvt_pk_bf16_f32 v53, v58, v59
    v_exp_f32 v60, v76
    v_exp_f32 v61, v77
    v_exp_f32_e64 v62, v78
    v_exp_f32 v63, v79
    s_waitcnt lgkmcnt(3)
    v_mfma_f32_32x32x16_bf16 v[64:79], v[32:35], v[16:19], v[112:127]
    v_cvt_pk_bf16_f32 v54, v60, v61
    v_cvt_pk_bf16_f32 v55, v62, v63
    v_exp_f32 v56, v80
    v_exp_f32 v57, v81
    v_exp_f32_e64 v58, v82
    v_exp_f32 v59, v83
    s_waitcnt lgkmcnt(0)
    v_mfma_f32_32x32x16_bf16 v[96:111], v[44:47], v[52:55], v[96:111]
    v_cvt_pk_bf16_f32 v48, v56, v57
    v_cvt_pk_bf16_f32 v49, v58, v59
    v_exp_f32 v60, v84
    v_exp_f32 v61, v85
    v_exp_f32 v62, v86
    v_exp_f32 v63, v87
    v_mfma_f32_32x32x8_bf16 v[64:79], v[36:37], v[20:21], v[64:79]
    ds_read_b128 v[32:35], v4 offset:23040
    ds_read_b64 v[36:37], v5 offset:23040
    v_cvt_pk_bf16_f32 v50, v60, v61
    v_cvt_pk_bf16_f32 v51, v62, v63
    v_exp_f32 v56, v88
    v_exp_f32 v57, v89
    v_exp_f32 v58, v90
    v_exp_f32 v59, v91
    v_mfma_f32_32x32x16_bf16 v[96:111], v[40:43], v[48:51], v[96:111]
    s_andn2_b64 exec, s[26:27], 0x40000000
    ds_read_b128 v[44:47], v6 offset:18560
    ds_read_b128 v[40:43], v6 offset:20480
    s_orn2_b64 exec, 0x40000000, 0
    v_cvt_pk_bf16_f32 v52, v56, v57
    v_cvt_pk_bf16_f32 v53, v58, v59
    v_exp_f32 v60, v92
    v_exp_f32 v61, v93
    v_exp_f32 v62, v94
    v_exp_f32 v63, v95
    v_add_u32 v4, 20480, v4
    v_add_u32 v5, 20480, v5
    v_add_u32 v6, 20480, v6
    s_add_u32 s23, s23, 1
    s_cmp_lt_u32 s23, 8
    s_cbranch_scc1 L_a_loop
    s_nop 0
    v_cvt_pk_bf16_f32 v54, v60, v61
    v_cvt_pk_bf16_f32 v55, v62, v63
    s_waitcnt lgkmcnt(0)
    s_nop 0
    v_mfma_f32_32x32x16_bf16 v[96:111], v[44:47], v[52:55], v[96:111]
L_a_fin:
    s_nop 15
    s_mov_b32 s3, 0x71800000
    v_cmp_gt_f32 vcc, s3, v108
    s_mov_b32 s3, 0xd800000
    v_cmp_lt_f32 s[6:7], s3, v108
    v_rcp_f32 v13, v108
    s_and_b64 vcc, vcc, s[6:7]
    s_cmp_eq_u64 vcc, -1
    s_cbranch_scc1 L_a_ok
    s_cmp_eq_u32 s22, 0
    s_cbranch_scc1 L_a_exact
L_a_ok:
    v_mul_f32 v96, v96, v13
    v_mul_f32 v97, v97, v13
    v_mul_f32 v98, v98, v13
    v_mul_f32 v99, v99, v13
    v_mul_f32 v100, v100, v13
    v_mul_f32 v101, v101, v13
    v_mul_f32 v102, v102, v13
    v_mul_f32 v103, v103, v13
    v_mul_f32 v104, v104, v13
    v_mul_f32 v105, v105, v13
    v_mul_f32 v106, v106, v13
    v_mul_f32 v107, v107, v13
    v_cvt_pk_bf16_f32 v56, v96, v97
    v_cvt_pk_bf16_f32 v57, v98, v99
    v_cvt_pk_bf16_f32 v58, v100, v101
    v_cvt_pk_bf16_f32 v59, v102, v103
    v_cvt_pk_bf16_f32 v60, v104, v105
    v_cvt_pk_bf16_f32 v61, v106, v107
    buffer_store_dwordx4 v[56:59], v7, s[8:11], s19 offen offset:1280 sc1
    s_mov_b64 exec, s[28:29]
    buffer_store_dwordx2 v[60:61], v10, s[8:11], s19 offen offset:2304 sc1
    s_mov_b64 exec, -1
    s_waitcnt vmcnt(0)
    s_barrier
    s_cmp_lg_u32 s14, 4
    s_cbranch_scc1 L_sig_a
    s_mov_b64 exec, 1
    v_mov_b32 v13, 0
    v_mov_b32_e64 v14, 1
    buffer_store_dword v14, v13, s[8:11], s45 offen offset:0 sc1
    s_mov_b64 exec, -1
L_sig_a:
    s_cmp_ge_u32 s14, 4
    s_cbranch_scc1 L_p_done
    s_mov_b32 s48, 0
L_p_poll:
    buffer_load_dword v24, v254, s[8:11], s46 offen sc1
    s_add_u32 s48, s48, 1
    s_waitcnt vmcnt(0)
    v_cmp_eq_u32 vcc, 1, v24
    s_cmp_eq_u64 vcc, -1
    s_cbranch_scc1 L_p_go
    s_sleep 1
    s_cmp_lt_u32 s48, 0x200000
    s_cbranch_scc1 L_p_poll
L_p_go:
    s_add_u32 s3, s42, 0
    buffer_load_dwordx4 v[64:67], v244, s[8:11], s3 offen offset:1280 sc1
    buffer_load_dwordx4 v[68:71], v244, s[8:11], s3 offen offset:1536 sc1
    s_add_u32 s3, s42, 327680
    buffer_load_dwordx4 v[72:75], v244, s[8:11], s3 offen offset:1280 sc1
    buffer_load_dwordx4 v[76:79], v244, s[8:11], s3 offen offset:1536 sc1
    s_add_u32 s3, s42, 655360
    buffer_load_dwordx4 v[80:83], v244, s[8:11], s3 offen offset:1280 sc1
    buffer_load_dwordx4 v[84:87], v244, s[8:11], s3 offen offset:1536 sc1
    s_add_u32 s3, s42, 983040
    buffer_load_dwordx4 v[88:91], v244, s[8:11], s3 offen offset:1280 sc1
    buffer_load_dwordx4 v[92:95], v244, s[8:11], s3 offen offset:1536 sc1
    s_add_u32 s3, s42, 0
    buffer_load_dwordx2 v[192:193], v245, s[8:11], s3 offen offset:2304 sc1
    buffer_load_dwordx2 v[194:195], v246, s[8:11], s3 offen offset:2304 sc1
    buffer_load_dwordx2 v[196:197], v245, s[8:11], s3 offen offset:2432 sc1
    buffer_load_dwordx2 v[198:199], v246, s[8:11], s3 offen offset:2432 sc1
    s_add_u32 s3, s42, 1310720
    buffer_load_dwordx4 v[96:99], v244, s[8:11], s3 offen offset:1280 sc1
    buffer_load_dwordx4 v[100:103], v244, s[8:11], s3 offen offset:1536 sc1
    ds_read_b64_tr_b16 v[0:1], v242 offset:0
    ds_read_b64_tr_b16 v[2:3], v242 offset:1280
    ds_read_b64_tr_b16 v[4:5], v242 offset:32
    ds_read_b64_tr_b16 v[6:7], v242 offset:1312
    ds_read_b64_tr_b16 v[8:9], v242 offset:64
    ds_read_b64_tr_b16 v[10:11], v242 offset:1344
    ds_read_b64_tr_b16 v[12:13], v242 offset:96
    ds_read_b64_tr_b16 v[14:15], v242 offset:1376
    ds_read_b64_tr_b16 v[16:17], v242 offset:128
    ds_read_b64_tr_b16 v[18:19], v242 offset:1408
    ds_read_b64_tr_b16 v[20:21], v242 offset:5120
    ds_read_b64_tr_b16 v[22:23], v242 offset:6400
.p2align 3
    s_waitcnt lgkmcnt(8)
    s_waitcnt vmcnt(12)
    v_mfma_f32_16x16x32_bf16 v[24:27], v[0:3], v[64:67], 0
    ds_read_b64_tr_b16 v[224:225], v242 offset:5152
    ds_read_b64_tr_b16 v[226:227], v242 offset:6432
    v_mfma_f32_16x16x32_bf16 v[28:31], v[0:3], v[68:71], 0
    ds_read_b64_tr_b16 v[228:229], v242 offset:5184
    s_add_u32 s3, s42, 1638400
    buffer_load_dwordx4 v[104:107], v244, s[8:11], s3 offen offset:1280 sc1
    v_mfma_f32_16x16x32_bf16 v[32:35], v[4:7], v[64:67], 0
    ds_read_b64_tr_b16 v[230:231], v242 offset:6464
    v_mfma_f32_16x16x32_bf16 v[36:39], v[4:7], v[68:71], 0
    s_waitcnt lgkmcnt(8)
    s_waitcnt vmcnt(13)
    v_mfma_f32_16x16x32_bf16 v[40:43], v[8:11], v[64:67], 0
    ds_read_b64_tr_b16 v[0:1], v242 offset:5216
    ds_read_b64_tr_b16 v[2:3], v242 offset:6496
    v_mfma_f32_16x16x32_bf16 v[44:47], v[8:11], v[68:71], 0
    ds_read_b64_tr_b16 v[4:5], v242 offset:5248
    buffer_load_dwordx4 v[108:111], v244, s[8:11], s3 offen offset:1536 sc1
    v_mfma_f32_16x16x32_bf16 v[48:51], v[12:15], v[64:67], 0
    ds_read_b64_tr_b16 v[6:7], v242 offset:6528
    v_mfma_f32_16x16x32_bf16 v[52:55], v[12:15], v[68:71], 0
    s_waitcnt lgkmcnt(8)
    s_waitcnt vmcnt(12)
    v_mfma_f32_16x16x32_bf16 v[56:59], v[16:19], v[64:67], 0
    ds_read_b64_tr_b16 v[8:9], v242 offset:10240
    ds_read_b64_tr_b16 v[10:11], v242 offset:11520
    v_mfma_f32_16x16x32_bf16 v[60:63], v[16:19], v[68:71], 0
    ds_read_b64_tr_b16 v[12:13], v242 offset:10272
    s_add_u32 s3, s42, 1966080
    buffer_load_dwordx4 v[112:115], v244, s[8:11], s3 offen offset:1280 sc1
    v_mfma_f32_16x16x32_bf16 v[24:27], v[20:23], v[72:75], v[24:27]
    ds_read_b64_tr_b16 v[14:15], v242 offset:11552
    v_mfma_f32_16x16x32_bf16 v[28:31], v[20:23], v[76:79], v[28:31]
    s_waitcnt lgkmcnt(8)
    s_waitcnt vmcnt(13)
    v_mfma_f32_16x16x32_bf16 v[32:35], v[224:227], v[72:75], v[32:35]
    ds_read_b64_tr_b16 v[16:17], v242 offset:10304
    ds_read_b64_tr_b16 v[18:19], v242 offset:11584
    v_mfma_f32_16x16x32_bf16 v[36:39], v[224:227], v[76:79], v[36:39]
    ds_read_b64_tr_b16 v[20:21], v242 offset:10336
    buffer_load_dwordx4 v[116:119], v244, s[8:11], s3 offen offset:1536 sc1
    v_mfma_f32_16x16x32_bf16 v[40:43], v[228:231], v[72:75], v[40:43]
    ds_read_b64_tr_b16 v[22:23], v242 offset:11616
    v_mfma_f32_16x16x32_bf16 v[44:47], v[228:231], v[76:79], v[44:47]
    s_waitcnt lgkmcnt(8)
    s_waitcnt vmcnt(14)
    v_mfma_f32_16x16x32_bf16 v[48:51], v[0:3], v[72:75], v[48:51]
    ds_read_b64_tr_b16 v[224:225], v242 offset:10368
    ds_read_b64_tr_b16 v[226:227], v242 offset:11648
    v_mfma_f32_16x16x32_bf16 v[52:55], v[0:3], v[76:79], v[52:55]
    ds_read_b64_tr_b16 v[228:229], v242 offset:15360
    v_mfma_f32_16x16x32_bf16 v[56:59], v[4:7], v[72:75], v[56:59]
    ds_read_b64_tr_b16 v[230:231], v242 offset:16640
    v_mfma_f32_16x16x32_bf16 v[60:63], v[4:7], v[76:79], v[60:63]
    s_waitcnt lgkmcnt(8)
    s_waitcnt vmcnt(12)
    v_mfma_f32_16x16x32_bf16 v[24:27], v[8:11], v[80:83], v[24:27]
    ds_read_b64_tr_b16 v[0:1], v242 offset:15392
    ds_read_b64_tr_b16 v[2:3], v242 offset:16672
    v_mfma_f32_16x16x32_bf16 v[28:31], v[8:11], v[84:87], v[28:31]
    ds_read_b64_tr_b16 v[4:5], v242 offset:15424
    s_add_u32 s3, s42, 2293760
    buffer_load_dwordx4 v[120:123], v244, s[8:11], s3 offen offset:1280 sc1
    v_mfma_f32_16x16x32_bf16 v[32:35], v[12:15], v[80:83], v[32:35]
    ds_read_b64_tr_b16 v[6:7], v242 offset:16704
    v_mfma_f32_16x16x32_bf16 v[36:39], v[12:15], v[84:87], v[36:39]
    s_waitcnt lgkmcnt(8)
    s_waitcnt vmcnt(13)
    v_mfma_f32_16x16x32_bf16 v[40:43], v[16:19], v[80:83], v[40:43]
    ds_read_b64_tr_b16 v[8:9], v242 offset:15456
    ds_read_b64_tr_b16 v[10:11], v242 offset:16736
    v_mfma_f32_16x16x32_bf16 v[44:47], v[16:19], v[84:87], v[44:47]
    ds_read_b64_tr_b16 v[12:13], v242 offset:15488
    buffer_load_dwordx4 v[124:127], v244, s[8:11], s3 offen offset:1536 sc1
    v_mfma_f32_16x16x32_bf16 v[48:51], v[20:23], v[80:83], v[48:51]
    ds_read_b64_tr_b16 v[14:15], v242 offset:16768
    v_mfma_f32_16x16x32_bf16 v[52:55], v[20:23], v[84:87], v[52:55]
    s_waitcnt lgkmcnt(8)
    s_waitcnt vmcnt(12)
    v_mfma_f32_16x16x32_bf16 v[56:59], v[224:227], v[80:83], v[56:59]
    ds_read_b64_tr_b16 v[16:17], v243 offset:20480
    ds_read_b64_tr_b16 v[18:19], v243 offset:21760
    v_mfma_f32_16x16x32_bf16 v[60:63], v[224:227], v[84:87], v[60:63]
    ds_read_b64_tr_b16 v[20:21], v243 offset:20512
    s_add_u32 s3, s42, 1310720
    buffer_load_dwordx2 v[200:201], v245, s[8:11], s3 offen offset:2304 sc1
    buffer_load_dwordx2 v[202:203], v246, s[8:11], s3 offen offset:2304 sc1
    v_mfma_f32_16x16x32_bf16 v[24:27], v[228:231], v[88:91], v[24:27]
    ds_read_b64_tr_b16 v[22:23], v243 offset:21792
    v_mfma_f32_16x16x32_bf16 v[28:31], v[228:231], v[92:95], v[28:31]
    s_waitcnt lgkmcnt(8)
    s_waitcnt vmcnt(14)
    v_mfma_f32_16x16x32_bf16 v[32:35], v[0:3], v[88:91], v[32:35]
    ds_read_b64_tr_b16 v[224:225], v243 offset:20544
    ds_read_b64_tr_b16 v[226:227], v243 offset:21824
    v_mfma_f32_16x16x32_bf16 v[36:39], v[0:3], v[92:95], v[36:39]
    ds_read_b64_tr_b16 v[228:229], v243 offset:20576
    buffer_load_dwordx2 v[204:205], v245, s[8:11], s3 offen offset:2432 sc1
    buffer_load_dwordx2 v[206:207], v246, s[8:11], s3 offen offset:2432 sc1
    v_mfma_f32_16x16x32_bf16 v[40:43], v[4:7], v[88:91], v[40:43]
    ds_read_b64_tr_b16 v[230:231], v243 offset:21856
    v_mfma_f32_16x16x32_bf16 v[44:47], v[4:7], v[92:95], v[44:47]
    s_waitcnt lgkmcnt(8)
    s_waitcnt vmcnt(16)
    v_mfma_f32_16x16x32_bf16 v[48:51], v[8:11], v[88:91], v[48:51]
    ds_read_b64_tr_b16 v[0:1], v243 offset:20608
    ds_read_b64_tr_b16 v[2:3], v243 offset:21888
    v_mfma_f32_16x16x32_bf16 v[52:55], v[8:11], v[92:95], v[52:55]
    ds_read_b64_tr_b16 v[4:5], v242 offset:20480
    v_mfma_f32_16x16x32_bf16 v[56:59], v[12:15], v[88:91], v[56:59]
    ds_read_b64_tr_b16 v[6:7], v242 offset:21760
    v_mfma_f32_16x16x32_bf16 v[60:63], v[12:15], v[92:95], v[60:63]
    s_waitcnt lgkmcnt(8)
    s_waitcnt vmcnt(12)
    v_mfma_f32_16x16x32_bf16 v[24:27], v[16:19], v[192:195], v[24:27]
    ds_read_b64_tr_b16 v[8:9], v242 offset:20512
    ds_read_b64_tr_b16 v[10:11], v242 offset:21792
    v_mfma_f32_16x16x32_bf16 v[28:31], v[16:19], v[196:199], v[28:31]
    ds_read_b64_tr_b16 v[12:13], v242 offset:20544
    s_add_u32 s3, s42, 2621440
    buffer_load_dwordx4 v[128:131], v244, s[8:11], s3 offen offset:1280 sc1
    v_mfma_f32_16x16x32_bf16 v[32:35], v[20:23], v[192:195], v[32:35]
    ds_read_b64_tr_b16 v[14:15], v242 offset:21824
    v_mfma_f32_16x16x32_bf16 v[36:39], v[20:23], v[196:199], v[36:39]
    s_waitcnt lgkmcnt(8)
    s_waitcnt vmcnt(13)
    v_mfma_f32_16x16x32_bf16 v[40:43], v[224:227], v[192:195], v[40:43]
    ds_read_b64_tr_b16 v[16:17], v242 offset:20576
    ds_read_b64_tr_b16 v[18:19], v242 offset:21856
    v_mfma_f32_16x16x32_bf16 v[44:47], v[224:227], v[196:199], v[44:47]
    ds_read_b64_tr_b16 v[20:21], v242 offset:20608
    buffer_load_dwordx4 v[132:135], v244, s[8:11], s3 offen offset:1536 sc1
    v_mfma_f32_16x16x32_bf16 v[48:51], v[228:231], v[192:195], v[48:51]
    ds_read_b64_tr_b16 v[22:23], v242 offset:21888
    v_mfma_f32_16x16x32_bf16 v[52:55], v[228:231], v[196:199], v[52:55]
    s_waitcnt lgkmcnt(8)
    s_waitcnt vmcnt(12)
    v_mfma_f32_16x16x32_bf16 v[56:59], v[0:3], v[192:195], v[56:59]
    ds_read_b64_tr_b16 v[224:225], v242 offset:25600
    ds_read_b64_tr_b16 v[226:227], v242 offset:26880
    v_mfma_f32_16x16x32_bf16 v[60:63], v[0:3], v[196:199], v[60:63]
    ds_read_b64_tr_b16 v[228:229], v242 offset:25632
    s_add_u32 s3, s42, 2949120
    buffer_load_dwordx4 v[136:139], v244, s[8:11], s3 offen offset:1280 sc1
    v_mfma_f32_16x16x32_bf16 v[24:27], v[4:7], v[96:99], v[24:27]
    ds_read_b64_tr_b16 v[230:231], v242 offset:26912
    v_mfma_f32_16x16x32_bf16 v[28:31], v[4:7], v[100:103], v[28:31]
    s_waitcnt lgkmcnt(8)
    s_waitcnt vmcnt(13)
    v_mfma_f32_16x16x32_bf16 v[32:35], v[8:11], v[96:99], v[32:35]
    ds_read_b64_tr_b16 v[0:1], v242 offset:25664
    ds_read_b64_tr_b16 v[2:3], v242 offset:26944
    v_mfma_f32_16x16x32_bf16 v[36:39], v[8:11], v[100:103], v[36:39]
    ds_read_b64_tr_b16 v[4:5], v242 offset:25696
    buffer_load_dwordx4 v[140:143], v244, s[8:11], s3 offen offset:1536 sc1
    v_mfma_f32_16x16x32_bf16 v[40:43], v[12:15], v[96:99], v[40:43]
    ds_read_b64_tr_b16 v[6:7], v242 offset:26976
    v_mfma_f32_16x16x32_bf16 v[44:47], v[12:15], v[100:103], v[44:47]
    s_waitcnt lgkmcnt(8)
    s_waitcnt vmcnt(14)
    v_mfma_f32_16x16x32_bf16 v[48:51], v[16:19], v[96:99], v[48:51]
    ds_read_b64_tr_b16 v[8:9], v242 offset:25728
    ds_read_b64_tr_b16 v[10:11], v242 offset:27008
    v_mfma_f32_16x16x32_bf16 v[52:55], v[16:19], v[100:103], v[52:55]
    ds_read_b64_tr_b16 v[12:13], v242 offset:30720
    v_mfma_f32_16x16x32_bf16 v[56:59], v[20:23], v[96:99], v[56:59]
    ds_read_b64_tr_b16 v[14:15], v242 offset:32000
    v_mfma_f32_16x16x32_bf16 v[60:63], v[20:23], v[100:103], v[60:63]
    s_waitcnt lgkmcnt(8)
    s_waitcnt vmcnt(12)
    v_mfma_f32_16x16x32_bf16 v[24:27], v[224:227], v[104:107], v[24:27]
    ds_read_b64_tr_b16 v[16:17], v242 offset:30752
    ds_read_b64_tr_b16 v[18:19], v242 offset:32032
    v_mfma_f32_16x16x32_bf16 v[28:31], v[224:227], v[108:111], v[28:31]
    ds_read_b64_tr_b16 v[20:21], v242 offset:30784
    s_add_u32 s3, s42, 3276800
    buffer_load_dwordx4 v[144:147], v244, s[8:11], s3 offen offset:1280 sc1
    v_mfma_f32_16x16x32_bf16 v[32:35], v[228:231], v[104:107], v[32:35]
    ds_read_b64_tr_b16 v[22:23], v242 offset:32064
    v_mfma_f32_16x16x32_bf16 v[36:39], v[228:231], v[108:111], v[36:39]
    s_waitcnt lgkmcnt(8)
    s_waitcnt vmcnt(13)
    v_mfma_f32_16x16x32_bf16 v[40:43], v[0:3], v[104:107], v[40:43]
    ds_read_b64_tr_b16 v[224:225], v242 offset:30816
    ds_read_b64_tr_b16 v[226:227], v242 offset:32096
    v_mfma_f32_16x16x32_bf16 v[44:47], v[0:3], v[108:111], v[44:47]
    ds_read_b64_tr_b16 v[228:229], v242 offset:30848
    buffer_load_dwordx4 v[148:151], v244, s[8:11], s3 offen offset:1536 sc1
    v_mfma_f32_16x16x32_bf16 v[48:51], v[4:7], v[104:107], v[48:51]
    ds_read_b64_tr_b16 v[230:231], v242 offset:32128
    v_mfma_f32_16x16x32_bf16 v[52:55], v[4:7], v[108:111], v[52:55]
    s_waitcnt lgkmcnt(8)
    s_waitcnt vmcnt(12)
    v_mfma_f32_16x16x32_bf16 v[56:59], v[8:11], v[104:107], v[56:59]
    ds_read_b64_tr_b16 v[0:1], v242 offset:35840
    ds_read_b64_tr_b16 v[2:3], v242 offset:37120
    v_mfma_f32_16x16x32_bf16 v[60:63], v[8:11], v[108:111], v[60:63]
    ds_read_b64_tr_b16 v[4:5], v242 offset:35872
    s_add_u32 s3, s42, 3604480
    buffer_load_dwordx4 v[152:155], v244, s[8:11], s3 offen offset:1280 sc1
    v_mfma_f32_16x16x32_bf16 v[24:27], v[12:15], v[112:115], v[24:27]
    ds_read_b64_tr_b16 v[6:7], v242 offset:37152
    v_mfma_f32_16x16x32_bf16 v[28:31], v[12:15], v[116:119], v[28:31]
    s_waitcnt lgkmcnt(8)
    s_waitcnt vmcnt(13)
    v_mfma_f32_16x16x32_bf16 v[32:35], v[16:19], v[112:115], v[32:35]
    ds_read_b64_tr_b16 v[8:9], v242 offset:35904
    ds_read_b64_tr_b16 v[10:11], v242 offset:37184
    v_mfma_f32_16x16x32_bf16 v[36:39], v[16:19], v[116:119], v[36:39]
    ds_read_b64_tr_b16 v[12:13], v242 offset:35936
    buffer_load_dwordx4 v[156:159], v244, s[8:11], s3 offen offset:1536 sc1
    v_mfma_f32_16x16x32_bf16 v[40:43], v[20:23], v[112:115], v[40:43]
    ds_read_b64_tr_b16 v[14:15], v242 offset:37216
    v_mfma_f32_16x16x32_bf16 v[44:47], v[20:23], v[116:119], v[44:47]
    s_waitcnt lgkmcnt(8)
    s_waitcnt vmcnt(14)
    v_mfma_f32_16x16x32_bf16 v[48:51], v[224:227], v[112:115], v[48:51]
    ds_read_b64_tr_b16 v[16:17], v242 offset:35968
    ds_read_b64_tr_b16 v[18:19], v242 offset:37248
    v_mfma_f32_16x16x32_bf16 v[52:55], v[224:227], v[116:119], v[52:55]
    ds_read_b64_tr_b16 v[20:21], v243 offset:25600
    v_mfma_f32_16x16x32_bf16 v[56:59], v[228:231], v[112:115], v[56:59]
    ds_read_b64_tr_b16 v[22:23], v243 offset:26880
    v_mfma_f32_16x16x32_bf16 v[60:63], v[228:231], v[116:119], v[60:63]
    s_waitcnt lgkmcnt(8)
    s_waitcnt vmcnt(12)
    v_mfma_f32_16x16x32_bf16 v[24:27], v[0:3], v[120:123], v[24:27]
    ds_read_b64_tr_b16 v[224:225], v243 offset:25632
    ds_read_b64_tr_b16 v[226:227], v243 offset:26912
    v_mfma_f32_16x16x32_bf16 v[28:31], v[0:3], v[124:127], v[28:31]
    ds_read_b64_tr_b16 v[228:229], v243 offset:25664
    s_add_u32 s3, s42, 2621440
    buffer_load_dwordx2 v[208:209], v245, s[8:11], s3 offen offset:2304 sc1
    buffer_load_dwordx2 v[210:211], v246, s[8:11], s3 offen offset:2304 sc1
    v_mfma_f32_16x16x32_bf16 v[32:35], v[4:7], v[120:123], v[32:35]
    ds_read_b64_tr_b16 v[230:231], v243 offset:26944
    v_mfma_f32_16x16x32_bf16 v[36:39], v[4:7], v[124:127], v[36:39]
    s_waitcnt lgkmcnt(8)
    s_waitcnt vmcnt(14)
    v_mfma_f32_16x16x32_bf16 v[40:43], v[8:11], v[120:123], v[40:43]
    ds_read_b64_tr_b16 v[0:1], v243 offset:25696
    ds_read_b64_tr_b16 v[2:3], v243 offset:26976
    v_mfma_f32_16x16x32_bf16 v[44:47], v[8:11], v[124:127], v[44:47]
    ds_read_b64_tr_b16 v[4:5], v243 offset:25728
    buffer_load_dwordx2 v[212:213], v245, s[8:11], s3 offen offset:2432 sc1
    buffer_load_dwordx2 v[214:215], v246, s[8:11], s3 offen offset:2432 sc1
    v_mfma_f32_16x16x32_bf16 v[48:51], v[12:15], v[120:123], v[48:51]
    ds_read_b64_tr_b16 v[6:7], v243 offset:27008
    v_mfma_f32_16x16x32_bf16 v[52:55], v[12:15], v[124:127], v[52:55]
    s_waitcnt lgkmcnt(8)
    s_waitcnt vmcnt(12)
    v_mfma_f32_16x16x32_bf16 v[56:59], v[16:19], v[120:123], v[56:59]
    ds_read_b64_tr_b16 v[8:9], v242 offset:40960
    ds_read_b64_tr_b16 v[10:11], v242 offset:42240
    v_mfma_f32_16x16x32_bf16 v[60:63], v[16:19], v[124:127], v[60:63]
    ds_read_b64_tr_b16 v[12:13], v242 offset:40992
    s_add_u32 s3, s42, 3932160
    buffer_load_dwordx4 v[160:163], v244, s[8:11], s3 offen offset:1280 sc1
    v_mfma_f32_16x16x32_bf16 v[24:27], v[20:23], v[200:203], v[24:27]
    ds_read_b64_tr_b16 v[14:15], v242 offset:42272
    v_mfma_f32_16x16x32_bf16 v[28:31], v[20:23], v[204:207], v[28:31]
    s_waitcnt lgkmcnt(8)
    s_waitcnt vmcnt(13)
    v_mfma_f32_16x16x32_bf16 v[32:35], v[224:227], v[200:203], v[32:35]
    ds_read_b64_tr_b16 v[16:17], v242 offset:41024
    ds_read_b64_tr_b16 v[18:19], v242 offset:42304
    v_mfma_f32_16x16x32_bf16 v[36:39], v[224:227], v[204:207], v[36:39]
    ds_read_b64_tr_b16 v[20:21], v242 offset:41056
    buffer_load_dwordx4 v[164:167], v244, s[8:11], s3 offen offset:1536 sc1
    v_mfma_f32_16x16x32_bf16 v[40:43], v[228:231], v[200:203], v[40:43]
    ds_read_b64_tr_b16 v[22:23], v242 offset:42336
    v_mfma_f32_16x16x32_bf16 v[44:47], v[228:231], v[204:207], v[44:47]
    s_waitcnt lgkmcnt(8)
    s_waitcnt vmcnt(14)
    v_mfma_f32_16x16x32_bf16 v[48:51], v[0:3], v[200:203], v[48:51]
    ds_read_b64_tr_b16 v[224:225], v242 offset:41088
    ds_read_b64_tr_b16 v[226:227], v242 offset:42368
    v_mfma_f32_16x16x32_bf16 v[52:55], v[0:3], v[204:207], v[52:55]
    ds_read_b64_tr_b16 v[228:229], v242 offset:46080
    v_mfma_f32_16x16x32_bf16 v[56:59], v[4:7], v[200:203], v[56:59]
    ds_read_b64_tr_b16 v[230:231], v242 offset:47360
    v_mfma_f32_16x16x32_bf16 v[60:63], v[4:7], v[204:207], v[60:63]
    s_waitcnt lgkmcnt(8)
    s_waitcnt vmcnt(12)
    v_mfma_f32_16x16x32_bf16 v[24:27], v[8:11], v[128:131], v[24:27]
    ds_read_b64_tr_b16 v[0:1], v242 offset:46112
    ds_read_b64_tr_b16 v[2:3], v242 offset:47392
    v_mfma_f32_16x16x32_bf16 v[28:31], v[8:11], v[132:135], v[28:31]
    ds_read_b64_tr_b16 v[4:5], v242 offset:46144
    s_add_u32 s3, s42, 4259840
    buffer_load_dwordx4 v[168:171], v244, s[8:11], s3 offen offset:1280 sc1
    v_mfma_f32_16x16x32_bf16 v[32:35], v[12:15], v[128:131], v[32:35]
    ds_read_b64_tr_b16 v[6:7], v242 offset:47424
    v_mfma_f32_16x16x32_bf16 v[36:39], v[12:15], v[132:135], v[36:39]
    s_waitcnt lgkmcnt(8)
    s_waitcnt vmcnt(13)
    v_mfma_f32_16x16x32_bf16 v[40:43], v[16:19], v[128:131], v[40:43]
    ds_read_b64_tr_b16 v[8:9], v242 offset:46176
    ds_read_b64_tr_b16 v[10:11], v242 offset:47456
    v_mfma_f32_16x16x32_bf16 v[44:47], v[16:19], v[132:135], v[44:47]
    ds_read_b64_tr_b16 v[12:13], v242 offset:46208
    buffer_load_dwordx4 v[172:175], v244, s[8:11], s3 offen offset:1536 sc1
    v_mfma_f32_16x16x32_bf16 v[48:51], v[20:23], v[128:131], v[48:51]
    ds_read_b64_tr_b16 v[14:15], v242 offset:47488
    v_mfma_f32_16x16x32_bf16 v[52:55], v[20:23], v[132:135], v[52:55]
    s_waitcnt lgkmcnt(8)
    s_waitcnt vmcnt(12)
    v_mfma_f32_16x16x32_bf16 v[56:59], v[224:227], v[128:131], v[56:59]
    ds_read_b64_tr_b16 v[16:17], v242 offset:51200
    ds_read_b64_tr_b16 v[18:19], v242 offset:52480
    v_mfma_f32_16x16x32_bf16 v[60:63], v[224:227], v[132:135], v[60:63]
    ds_read_b64_tr_b16 v[20:21], v242 offset:51232
    s_add_u32 s3, s42, 4587520
    buffer_load_dwordx4 v[176:179], v244, s[8:11], s3 offen offset:1280 sc1
    v_mfma_f32_16x16x32_bf16 v[24:27], v[228:231], v[136:139], v[24:27]
    ds_read_b64_tr_b16 v[22:23], v242 offset:52512
    v_mfma_f32_16x16x32_bf16 v[28:31], v[228:231], v[140:143], v[28:31]
    s_waitcnt lgkmcnt(8)
    s_waitcnt vmcnt(13)
    v_mfma_f32_16x16x32_bf16 v[32:35], v[0:3], v[136:139], v[32:35]
    ds_read_b64_tr_b16 v[224:225], v242 offset:51264
    ds_read_b64_tr_b16 v[226:227], v242 offset:52544
    v_mfma_f32_16x16x32_bf16 v[36:39], v[0:3], v[140:143], v[36:39]
    ds_read_b64_tr_b16 v[228:229], v242 offset:51296
    buffer_load_dwordx4 v[180:183], v244, s[8:11], s3 offen offset:1536 sc1
    v_mfma_f32_16x16x32_bf16 v[40:43], v[4:7], v[136:139], v[40:43]
    ds_read_b64_tr_b16 v[230:231], v242 offset:52576
    v_mfma_f32_16x16x32_bf16 v[44:47], v[4:7], v[140:143], v[44:47]
    s_waitcnt lgkmcnt(8)
    s_waitcnt vmcnt(14)
    v_mfma_f32_16x16x32_bf16 v[48:51], v[8:11], v[136:139], v[48:51]
    ds_read_b64_tr_b16 v[0:1], v242 offset:51328
    ds_read_b64_tr_b16 v[2:3], v242 offset:52608
    v_mfma_f32_16x16x32_bf16 v[52:55], v[8:11], v[140:143], v[52:55]
    ds_read_b64_tr_b16 v[4:5], v242 offset:56320
    v_mfma_f32_16x16x32_bf16 v[56:59], v[12:15], v[136:139], v[56:59]
    ds_read_b64_tr_b16 v[6:7], v242 offset:57600
    v_mfma_f32_16x16x32_bf16 v[60:63], v[12:15], v[140:143], v[60:63]
    s_waitcnt lgkmcnt(8)
    s_waitcnt vmcnt(12)
    v_mfma_f32_16x16x32_bf16 v[24:27], v[16:19], v[144:147], v[24:27]
    ds_read_b64_tr_b16 v[8:9], v242 offset:56352
    ds_read_b64_tr_b16 v[10:11], v242 offset:57632
    v_mfma_f32_16x16x32_bf16 v[28:31], v[16:19], v[148:151], v[28:31]
    ds_read_b64_tr_b16 v[12:13], v242 offset:56384
    s_add_u32 s3, s42, 4915200
    buffer_load_dwordx4 v[184:187], v244, s[8:11], s3 offen offset:1280 sc1
    v_mfma_f32_16x16x32_bf16 v[32:35], v[20:23], v[144:147], v[32:35]
    ds_read_b64_tr_b16 v[14:15], v242 offset:57664
    v_mfma_f32_16x16x32_bf16 v[36:39], v[20:23], v[148:151], v[36:39]
    s_waitcnt lgkmcnt(8)
    s_waitcnt vmcnt(13)
    v_mfma_f32_16x16x32_bf16 v[40:43], v[224:227], v[144:147], v[40:43]
    ds_read_b64_tr_b16 v[16:17], v242 offset:56416
    ds_read_b64_tr_b16 v[18:19], v242 offset:57696
    v_mfma_f32_16x16x32_bf16 v[44:47], v[224:227], v[148:151], v[44:47]
    ds_read_b64_tr_b16 v[20:21], v242 offset:56448
    buffer_load_dwordx4 v[188:191], v244, s[8:11], s3 offen offset:1536 sc1
    v_mfma_f32_16x16x32_bf16 v[48:51], v[228:231], v[144:147], v[48:51]
    ds_read_b64_tr_b16 v[22:23], v242 offset:57728
    v_mfma_f32_16x16x32_bf16 v[52:55], v[228:231], v[148:151], v[52:55]
    s_waitcnt lgkmcnt(8)
    s_waitcnt vmcnt(12)
    v_mfma_f32_16x16x32_bf16 v[56:59], v[0:3], v[144:147], v[56:59]
    ds_read_b64_tr_b16 v[224:225], v243 offset:30720
    ds_read_b64_tr_b16 v[226:227], v243 offset:32000
    v_mfma_f32_16x16x32_bf16 v[60:63], v[0:3], v[148:151], v[60:63]
    ds_read_b64_tr_b16 v[228:229], v243 offset:30752
    s_add_u32 s3, s42, 3932160
    buffer_load_dwordx2 v[216:217], v245, s[8:11], s3 offen offset:2304 sc1
    buffer_load_dwordx2 v[218:219], v246, s[8:11], s3 offen offset:2304 sc1
    v_mfma_f32_16x16x32_bf16 v[24:27], v[4:7], v[152:155], v[24:27]
    ds_read_b64_tr_b16 v[230:231], v243 offset:32032
    v_mfma_f32_16x16x32_bf16 v[28:31], v[4:7], v[156:159], v[28:31]
    s_waitcnt lgkmcnt(8)
    s_waitcnt vmcnt(14)
    v_mfma_f32_16x16x32_bf16 v[32:35], v[8:11], v[152:155], v[32:35]
    ds_read_b64_tr_b16 v[0:1], v243 offset:30784
    ds_read_b64_tr_b16 v[2:3], v243 offset:32064
    v_mfma_f32_16x16x32_bf16 v[36:39], v[8:11], v[156:159], v[36:39]
    ds_read_b64_tr_b16 v[4:5], v243 offset:30816
    buffer_load_dwordx2 v[220:221], v245, s[8:11], s3 offen offset:2432 sc1
    buffer_load_dwordx2 v[222:223], v246, s[8:11], s3 offen offset:2432 sc1
    v_mfma_f32_16x16x32_bf16 v[40:43], v[12:15], v[152:155], v[40:43]
    ds_read_b64_tr_b16 v[6:7], v243 offset:32096
    v_mfma_f32_16x16x32_bf16 v[44:47], v[12:15], v[156:159], v[44:47]
    s_waitcnt lgkmcnt(8)
    s_waitcnt vmcnt(16)
    v_mfma_f32_16x16x32_bf16 v[48:51], v[16:19], v[152:155], v[48:51]
    ds_read_b64_tr_b16 v[8:9], v243 offset:30848
    ds_read_b64_tr_b16 v[10:11], v243 offset:32128
    v_mfma_f32_16x16x32_bf16 v[52:55], v[16:19], v[156:159], v[52:55]
    ds_read_b64_tr_b16 v[12:13], v243 offset:0
    v_mfma_f32_16x16x32_bf16 v[56:59], v[20:23], v[152:155], v[56:59]
    ds_read_b64_tr_b16 v[14:15], v243 offset:1280
    v_mfma_f32_16x16x32_bf16 v[60:63], v[20:23], v[156:159], v[60:63]
    s_waitcnt lgkmcnt(8)
    s_waitcnt vmcnt(12)
    v_mfma_f32_16x16x32_bf16 v[24:27], v[224:227], v[208:211], v[24:27]
    ds_read_b64_tr_b16 v[16:17], v243 offset:32
    ds_read_b64_tr_b16 v[18:19], v243 offset:1312
    v_mfma_f32_16x16x32_bf16 v[28:31], v[224:227], v[212:215], v[28:31]
    ds_read_b64_tr_b16 v[20:21], v243 offset:64
    v_mfma_f32_16x16x32_bf16 v[32:35], v[228:231], v[208:211], v[32:35]
    ds_read_b64_tr_b16 v[22:23], v243 offset:1344
    v_mfma_f32_16x16x32_bf16 v[36:39], v[228:231], v[212:215], v[36:39]
    s_waitcnt lgkmcnt(8)
    s_waitcnt vmcnt(12)
    v_mfma_f32_16x16x32_bf16 v[40:43], v[0:3], v[208:211], v[40:43]
    ds_read_b64_tr_b16 v[224:225], v243 offset:96
    ds_read_b64_tr_b16 v[226:227], v243 offset:1376
    v_mfma_f32_16x16x32_bf16 v[44:47], v[0:3], v[212:215], v[44:47]
    ds_read_b64_tr_b16 v[228:229], v243 offset:128
    v_mfma_f32_16x16x32_bf16 v[48:51], v[4:7], v[208:211], v[48:51]
    ds_read_b64_tr_b16 v[230:231], v243 offset:1408
    v_mfma_f32_16x16x32_bf16 v[52:55], v[4:7], v[212:215], v[52:55]
    s_waitcnt lgkmcnt(8)
    s_waitcnt vmcnt(10)
    v_mfma_f32_16x16x32_bf16 v[56:59], v[8:11], v[208:211], v[56:59]
    ds_read_b64_tr_b16 v[0:1], v243 offset:5120
    ds_read_b64_tr_b16 v[2:3], v243 offset:6400
    v_mfma_f32_16x16x32_bf16 v[60:63], v[8:11], v[212:215], v[60:63]
    ds_read_b64_tr_b16 v[4:5], v243 offset:5152
    v_mfma_f32_16x16x32_bf16 v[24:27], v[12:15], v[160:163], v[24:27]
    ds_read_b64_tr_b16 v[6:7], v243 offset:6432
    v_mfma_f32_16x16x32_bf16 v[28:31], v[12:15], v[164:167], v[28:31]
    s_waitcnt lgkmcnt(8)
    s_waitcnt vmcnt(10)
    v_mfma_f32_16x16x32_bf16 v[32:35], v[16:19], v[160:163], v[32:35]
    ds_read_b64_tr_b16 v[8:9], v243 offset:5184
    ds_read_b64_tr_b16 v[10:11], v243 offset:6464
    v_mfma_f32_16x16x32_bf16 v[36:39], v[16:19], v[164:167], v[36:39]
    ds_read_b64_tr_b16 v[12:13], v243 offset:5216
    v_mfma_f32_16x16x32_bf16 v[40:43], v[20:23], v[160:163], v[40:43]
    ds_read_b64_tr_b16 v[14:15], v243 offset:6496
    v_mfma_f32_16x16x32_bf16 v[44:47], v[20:23], v[164:167], v[44:47]
    s_waitcnt lgkmcnt(8)
    s_waitcnt vmcnt(10)
    v_mfma_f32_16x16x32_bf16 v[48:51], v[224:227], v[160:163], v[48:51]
    ds_read_b64_tr_b16 v[16:17], v243 offset:5248
    ds_read_b64_tr_b16 v[18:19], v243 offset:6528
    v_mfma_f32_16x16x32_bf16 v[52:55], v[224:227], v[164:167], v[52:55]
    ds_read_b64_tr_b16 v[20:21], v243 offset:10240
    v_mfma_f32_16x16x32_bf16 v[56:59], v[228:231], v[160:163], v[56:59]
    ds_read_b64_tr_b16 v[22:23], v243 offset:11520
    v_mfma_f32_16x16x32_bf16 v[60:63], v[228:231], v[164:167], v[60:63]
    s_waitcnt lgkmcnt(8)
    s_waitcnt vmcnt(8)
    v_mfma_f32_16x16x32_bf16 v[24:27], v[0:3], v[168:171], v[24:27]
    ds_read_b64_tr_b16 v[224:225], v243 offset:10272
    ds_read_b64_tr_b16 v[226:227], v243 offset:11552
    v_mfma_f32_16x16x32_bf16 v[28:31], v[0:3], v[172:175], v[28:31]
    ds_read_b64_tr_b16 v[228:229], v243 offset:10304
    v_mfma_f32_16x16x32_bf16 v[32:35], v[4:7], v[168:171], v[32:35]
    ds_read_b64_tr_b16 v[230:231], v243 offset:11584
    v_mfma_f32_16x16x32_bf16 v[36:39], v[4:7], v[172:175], v[36:39]
    s_waitcnt lgkmcnt(8)
    s_waitcnt vmcnt(8)
    v_mfma_f32_16x16x32_bf16 v[40:43], v[8:11], v[168:171], v[40:43]
    ds_read_b64_tr_b16 v[0:1], v243 offset:10336
    ds_read_b64_tr_b16 v[2:3], v243 offset:11616
    v_mfma_f32_16x16x32_bf16 v[44:47], v[8:11], v[172:175], v[44:47]
    ds_read_b64_tr_b16 v[4:5], v243 offset:10368
    v_mfma_f32_16x16x32_bf16 v[48:51], v[12:15], v[168:171], v[48:51]
    ds_read_b64_tr_b16 v[6:7], v243 offset:11648
    v_mfma_f32_16x16x32_bf16 v[52:55], v[12:15], v[172:175], v[52:55]
    s_waitcnt lgkmcnt(8)
    s_waitcnt vmcnt(6)
    v_mfma_f32_16x16x32_bf16 v[56:59], v[16:19], v[168:171], v[56:59]
    ds_read_b64_tr_b16 v[8:9], v243 offset:15360
    ds_read_b64_tr_b16 v[10:11], v243 offset:16640
    v_mfma_f32_16x16x32_bf16 v[60:63], v[16:19], v[172:175], v[60:63]
    ds_read_b64_tr_b16 v[12:13], v243 offset:15392
    v_mfma_f32_16x16x32_bf16 v[24:27], v[20:23], v[176:179], v[24:27]
    ds_read_b64_tr_b16 v[14:15], v243 offset:16672
    v_mfma_f32_16x16x32_bf16 v[28:31], v[20:23], v[180:183], v[28:31]
    s_waitcnt lgkmcnt(8)
    s_waitcnt vmcnt(6)
    v_mfma_f32_16x16x32_bf16 v[32:35], v[224:227], v[176:179], v[32:35]
    ds_read_b64_tr_b16 v[16:17], v243 offset:15424
    ds_read_b64_tr_b16 v[18:19], v243 offset:16704
    v_mfma_f32_16x16x32_bf16 v[36:39], v[224:227], v[180:183], v[36:39]
    ds_read_b64_tr_b16 v[20:21], v243 offset:15456
    v_mfma_f32_16x16x32_bf16 v[40:43], v[228:231], v[176:179], v[40:43]
    ds_read_b64_tr_b16 v[22:23], v243 offset:16736
    v_mfma_f32_16x16x32_bf16 v[44:47], v[228:231], v[180:183], v[44:47]
    s_waitcnt lgkmcnt(8)
    s_waitcnt vmcnt(6)
    v_mfma_f32_16x16x32_bf16 v[48:51], v[0:3], v[176:179], v[48:51]
    ds_read_b64_tr_b16 v[224:225], v243 offset:15488
    ds_read_b64_tr_b16 v[226:227], v243 offset:16768
    v_mfma_f32_16x16x32_bf16 v[52:55], v[0:3], v[180:183], v[52:55]
    ds_read_b64_tr_b16 v[228:229], v243 offset:35840
    v_mfma_f32_16x16x32_bf16 v[56:59], v[4:7], v[176:179], v[56:59]
    ds_read_b64_tr_b16 v[230:231], v243 offset:37120
    v_mfma_f32_16x16x32_bf16 v[60:63], v[4:7], v[180:183], v[60:63]
    s_waitcnt lgkmcnt(8)
    s_waitcnt vmcnt(4)
    v_mfma_f32_16x16x32_bf16 v[24:27], v[8:11], v[184:187], v[24:27]
    ds_read_b64_tr_b16 v[0:1], v243 offset:35872
    ds_read_b64_tr_b16 v[2:3], v243 offset:37152
    v_mfma_f32_16x16x32_bf16 v[28:31], v[8:11], v[188:191], v[28:31]
    ds_read_b64_tr_b16 v[4:5], v243 offset:35904
    v_mfma_f32_16x16x32_bf16 v[32:35], v[12:15], v[184:187], v[32:35]
    ds_read_b64_tr_b16 v[6:7], v243 offset:37184
    v_mfma_f32_16x16x32_bf16 v[36:39], v[12:15], v[188:191], v[36:39]
    s_waitcnt lgkmcnt(8)
    s_waitcnt vmcnt(4)
    v_mfma_f32_16x16x32_bf16 v[40:43], v[16:19], v[184:187], v[40:43]
    ds_read_b64_tr_b16 v[8:9], v243 offset:35936
    ds_read_b64_tr_b16 v[10:11], v243 offset:37216
    v_mfma_f32_16x16x32_bf16 v[44:47], v[16:19], v[188:191], v[44:47]
    ds_read_b64_tr_b16 v[12:13], v243 offset:35968
    v_mfma_f32_16x16x32_bf16 v[48:51], v[20:23], v[184:187], v[48:51]
    ds_read_b64_tr_b16 v[14:15], v243 offset:37248
    v_mfma_f32_16x16x32_bf16 v[52:55], v[20:23], v[188:191], v[52:55]
    s_waitcnt lgkmcnt(8)
    s_waitcnt vmcnt(0)
    v_mfma_f32_16x16x32_bf16 v[56:59], v[224:227], v[184:187], v[56:59]
    v_mfma_f32_16x16x32_bf16 v[60:63], v[224:227], v[188:191], v[60:63]
    v_mfma_f32_16x16x32_bf16 v[24:27], v[228:231], v[216:219], v[24:27]
    v_mfma_f32_16x16x32_bf16 v[28:31], v[228:231], v[220:223], v[28:31]
    s_waitcnt lgkmcnt(4)
    s_waitcnt vmcnt(0)
    v_mfma_f32_16x16x32_bf16 v[32:35], v[0:3], v[216:219], v[32:35]
    v_mfma_f32_16x16x32_bf16 v[36:39], v[0:3], v[220:223], v[36:39]
    v_mfma_f32_16x16x32_bf16 v[40:43], v[4:7], v[216:219], v[40:43]
    v_mfma_f32_16x16x32_bf16 v[44:47], v[4:7], v[220:223], v[44:47]
    s_waitcnt lgkmcnt(0)
    s_waitcnt vmcnt(0)
    v_mfma_f32_16x16x32_bf16 v[48:51], v[8:11], v[216:219], v[48:51]
    v_mfma_f32_16x16x32_bf16 v[52:55], v[8:11], v[220:223], v[52:55]
    v_mfma_f32_16x16x32_bf16 v[56:59], v[12:15], v[216:219], v[56:59]
    v_mfma_f32_16x16x32_bf16 v[60:63], v[12:15], v[220:223], v[60:63]
    s_nop 7
    v_cvt_pk_bf16_f32 v24, v24, v25
    v_cvt_pk_bf16_f32 v25, v26, v27
    ds_write_b64 v247, v[24:25] offset:0
    v_cvt_pk_bf16_f32 v28, v28, v29
    v_cvt_pk_bf16_f32 v29, v30, v31
    ds_write_b64 v247, v[28:29] offset:2560
    v_cvt_pk_bf16_f32 v32, v32, v33
    v_cvt_pk_bf16_f32 v33, v34, v35
    ds_write_b64 v247, v[32:33] offset:32
    v_cvt_pk_bf16_f32 v36, v36, v37
    v_cvt_pk_bf16_f32 v37, v38, v39
    ds_write_b64 v247, v[36:37] offset:2592
    v_cvt_pk_bf16_f32 v40, v40, v41
    v_cvt_pk_bf16_f32 v41, v42, v43
    ds_write_b64 v247, v[40:41] offset:64
    v_cvt_pk_bf16_f32 v44, v44, v45
    v_cvt_pk_bf16_f32 v45, v46, v47
    ds_write_b64 v247, v[44:45] offset:2624
    v_cvt_pk_bf16_f32 v48, v48, v49
    v_cvt_pk_bf16_f32 v49, v50, v51
    ds_write_b64 v247, v[48:49] offset:96
    v_cvt_pk_bf16_f32 v52, v52, v53
    v_cvt_pk_bf16_f32 v53, v54, v55
    ds_write_b64 v247, v[52:53] offset:2656
    v_cvt_pk_bf16_f32 v56, v56, v57
    v_cvt_pk_bf16_f32 v57, v58, v59
    ds_write_b64 v247, v[56:57] offset:128
    v_cvt_pk_bf16_f32 v60, v60, v61
    v_cvt_pk_bf16_f32 v61, v62, v63
    ds_write_b64 v247, v[60:61] offset:2688
    s_waitcnt lgkmcnt(0)
    ds_read_b128 v[64:67], v248 offset:0
    ds_read_b128 v[68:71], v248 offset:1024
    ds_read_b128 v[72:75], v248 offset:2048
    ds_read_b128 v[76:79], v248 offset:3072
    ds_read_b128 v[80:83], v248 offset:4096
    s_waitcnt lgkmcnt(4)
    buffer_store_dwordx4 v[64:67], v249, s[36:39], s44 offen nt
    s_waitcnt lgkmcnt(3)
    buffer_store_dwordx4 v[68:71], v250, s[36:39], s44 offen nt
    s_waitcnt lgkmcnt(2)
    buffer_store_dwordx4 v[72:75], v251, s[36:39], s44 offen nt
    s_waitcnt lgkmcnt(1)
    buffer_store_dwordx4 v[76:79], v252, s[36:39], s44 offen nt
    s_waitcnt lgkmcnt(0)
    buffer_store_dwordx4 v[80:83], v253, s[36:39], s44 offen nt
L_p_done:
    s_endpgm
L_b_rem0:
    s_add_u32 m0, s25, 4096
    s_add_u32 s3, s30, 4096
    buffer_load_dwordx4 v7, s[8:11], s3 offen lds
    buffer_load_dwordx4 v7, s[8:11], s3 offen offset:1024 lds
L_b_rem1:
    s_add_u32 m0, s25, 6144
    s_add_u32 s3, s30, 6144
    buffer_load_dwordx4 v7, s[8:11], s3 offen lds
    buffer_load_dwordx4 v7, s[8:11], s3 offen offset:1024 lds
L_b_rem2:
    s_add_u32 m0, s25, 8192
    s_add_u32 s3, s30, 8192
    buffer_load_dwordx4 v7, s[8:11], s3 offen lds
    buffer_load_dwordx4 v7, s[8:11], s3 offen offset:1024 lds
L_b_rem3:
    s_add_u32 m0, s25, 10240
    s_add_u32 s3, s30, 10240
    buffer_load_dwordx4 v7, s[8:11], s3 offen lds
    buffer_load_dwordx4 v7, s[8:11], s3 offen offset:1024 lds
L_b_rem4:
    s_add_u32 m0, s25, 12288
    s_add_u32 s3, s30, 12288
    buffer_load_dwordx4 v7, s[8:11], s3 offen lds
    buffer_load_dwordx4 v7, s[8:11], s3 offen offset:1024 lds
L_b_rem5:
    s_add_u32 m0, s25, 14336
    s_add_u32 s3, s30, 14336
    buffer_load_dwordx4 v7, s[8:11], s3 offen lds
    buffer_load_dwordx4 v[24:27], v7, s[8:11], s19 offen
    s_mov_b64 exec, s[28:29]
    buffer_load_dwordx2 v[28:29], v8, s[8:11], s19 offen
    s_mov_b64 exec, -1
    s_branch L_b_rem6
L_a_exact:
    s_mov_b32 s22, 1
    v_mov_b32_e64 v11, v12
    s_mov_b32 s23, 0
    s_mov_b32 s3, s17
L_a_exact_loop:
    buffer_load_dwordx4 v[32:35], v7, s[8:11], s3 offen
    buffer_load_dwordx2 v[36:37], v8, s[8:11], s3 offen
    s_waitcnt vmcnt(0)
    v_mfma_f32_32x32x16_bf16 v[64:79], v[32:35], v[16:19], 0
    v_mfma_f32_32x32x8_bf16 v[64:79], v[36:37], v[20:21], v[64:79]
    s_nop 15
    s_nop 7
    v_max3_f32 v11, v64, v65, v11
    v_max3_f32 v11, v66, v67, v11
    v_max3_f32 v11, v68, v69, v11
    v_max3_f32 v11, v70, v71, v11
    v_max3_f32 v11, v72, v73, v11
    v_max3_f32 v11, v74, v75, v11
    v_max3_f32 v11, v76, v77, v11
    v_max3_f32 v11, v78, v79, v11
    s_add_u32 s3, s3, 2560
    s_add_u32 s23, s23, 1
    s_cmp_lt_u32 s23, 64
    s_cbranch_scc1 L_a_exact_loop
    v_mov_b32 v13, v11
    s_nop 1
    v_permlane32_swap_b32 v13, v11
    s_nop 1
    v_max_f32_e64 v11, v11, v13
    v_sub_f32 v11, 0xc2200000, v11
    v_mov_b32 v112, v11
    v_mov_b32 v96, 0
    v_mov_b32 v113, v11
    v_mov_b32 v97, 0
    v_mov_b32 v114, v11
    v_mov_b32 v98, 0
    v_mov_b32 v115, v11
    v_mov_b32 v99, 0
    v_mov_b32 v116, v11
    v_mov_b32 v100, 0
    v_mov_b32 v117, v11
    v_mov_b32 v101, 0
    v_mov_b32 v118, v11
    v_mov_b32 v102, 0
    v_mov_b32 v119, v11
    v_mov_b32 v103, 0
    v_mov_b32 v120, v11
    v_mov_b32 v104, 0
    v_mov_b32 v121, v11
    v_mov_b32 v105, 0
    v_mov_b32 v122, v11
    v_mov_b32 v106, 0
    v_mov_b32 v123, v11
    v_mov_b32 v107, 0
    v_mov_b32 v124, v11
    v_mov_b32 v108, 0
    v_mov_b32 v125, v11
    v_mov_b32 v109, 0
    v_mov_b32 v126, v11
    v_mov_b32 v110, 0
    v_mov_b32 v127, v11
    v_mov_b32 v111, 0
    s_mov_b32 s23, 0
    s_mov_b32 s3, s17
L_a_exact_loop2:
    buffer_load_dwordx4 v[32:35], v7, s[8:11], s3 offen
    buffer_load_dwordx2 v[36:37], v8, s[8:11], s3 offen
    s_andn2_b64 exec, s[26:27], 0x40000000
    buffer_load_dwordx4 v[40:43], v9, s[8:11], s3 offen
    buffer_load_dwordx4 v[44:47], v9, s[8:11], s3 offen offset:640
    s_mov_b64 exec, -1
    s_waitcnt vmcnt(0)
    v_mfma_f32_32x32x16_bf16 v[64:79], v[32:35], v[16:19], v[112:127]
    v_mfma_f32_32x32x8_bf16 v[64:79], v[36:37], v[20:21], v[64:79]
    s_nop 15
    s_nop 7
    v_exp_f32 v64, v64
    v_exp_f32 v65, v65
    v_exp_f32 v66, v66
    v_exp_f32 v67, v67
    v_exp_f32 v68, v68
    v_exp_f32 v69, v69
    v_exp_f32 v70, v70
    v_exp_f32 v71, v71
    v_exp_f32 v72, v72
    v_exp_f32 v73, v73
    v_exp_f32 v74, v74
    v_exp_f32 v75, v75
    v_exp_f32 v76, v76
    v_exp_f32 v77, v77
    v_exp_f32_e64 v78, v78
    v_exp_f32 v79, v79
    s_nop 1
    v_cvt_pk_bf16_f32 v48, v64, v65
    v_cvt_pk_bf16_f32 v49, v66, v67
    v_cvt_pk_bf16_f32 v50, v68, v69
    v_cvt_pk_bf16_f32 v51, v70, v71
    v_cvt_pk_bf16_f32 v52, v72, v73
    v_cvt_pk_bf16_f32 v53, v74, v75
    v_cvt_pk_bf16_f32 v54, v76, v77
    v_cvt_pk_bf16_f32 v55, v78, v79
    s_nop 1
    v_mfma_f32_32x32x16_bf16 v[96:111], v[40:43], v[48:51], v[96:111]
    v_mfma_f32_32x32x16_bf16 v[96:111], v[44:47], v[52:55], v[96:111]
    s_nop 15
    s_add_u32 s3, s3, 2560
    s_add_u32 s23, s23, 1
    s_cmp_lt_u32 s23, 64
    s_cbranch_scc1 L_a_exact_loop2
    s_branch L_a_fin
L_b_exact:
    s_mov_b32 s22, 1
    v_mov_b32 v11, v12
    ds_read_b128 v[32:35], v4 offset:20480
    ds_read_b64 v[36:37], v5 offset:20480
    s_waitcnt lgkmcnt(0)
    v_mfma_f32_32x32x16_bf16 v[64:79], v[32:35], v[16:19], v[128:143]
    v_mfma_f32_32x32x8_bf16 v[64:79], v[36:37], v[20:21], v[64:79]
    s_nop 15
    v_max3_f32 v11, v64, v65, v11
    v_max3_f32 v11, v66, v67, v11
    v_max3_f32 v11, v68, v69, v11
    v_max3_f32 v11, v70, v71, v11
    v_max3_f32 v11, v72, v73, v11
    v_max3_f32 v11, v74, v75, v11
    v_max3_f32 v11, v76, v77, v11
    v_max3_f32 v11, v78, v79, v11
    s_cmp_eq_u32 s21, 1
    s_cbranch_scc1 L_b_exact_done
    ds_read_b128 v[32:35], v4 offset:17920
    ds_read_b64 v[36:37], v5 offset:17920
    s_waitcnt lgkmcnt(0)
    v_mfma_f32_32x32x16_bf16 v[64:79], v[32:35], v[16:19], 0
    v_mfma_f32_32x32x8_bf16 v[64:79], v[36:37], v[20:21], v[64:79]
    s_nop 15
    v_max3_f32 v11, v64, v65, v11
    v_max3_f32 v11, v66, v67, v11
    v_max3_f32 v11, v68, v69, v11
    v_max3_f32 v11, v70, v71, v11
    v_max3_f32 v11, v72, v73, v11
    v_max3_f32 v11, v74, v75, v11
    v_max3_f32 v11, v76, v77, v11
    v_max3_f32 v11, v78, v79, v11
    s_cmp_eq_u32 s21, 2
    s_cbranch_scc1 L_b_exact_done
    ds_read_b128 v[32:35], v4 offset:15360
    ds_read_b64 v[36:37], v5 offset:15360
    s_waitcnt lgkmcnt(0)
    v_mfma_f32_32x32x16_bf16 v[64:79], v[32:35], v[16:19], 0
    v_mfma_f32_32x32x8_bf16 v[64:79], v[36:37], v[20:21], v[64:79]
    s_nop 15
    v_max3_f32 v11, v64, v65, v11
    v_max3_f32 v11, v66, v67, v11
    v_max3_f32 v11, v68, v69, v11
    v_max3_f32 v11, v70, v71, v11
    v_max3_f32 v11, v72, v73, v11
    v_max3_f32 v11, v74, v75, v11
    v_max3_f32 v11, v76, v77, v11
    v_max3_f32 v11, v78, v79, v11
    s_cmp_eq_u32 s21, 3
    s_cbranch_scc1 L_b_exact_done
    ds_read_b128 v[32:35], v4 offset:12800
    ds_read_b64 v[36:37], v5 offset:12800
    s_waitcnt lgkmcnt(0)
    v_mfma_f32_32x32x16_bf16 v[64:79], v[32:35], v[16:19], 0
    v_mfma_f32_32x32x8_bf16 v[64:79], v[36:37], v[20:21], v[64:79]
    s_nop 15
    v_max3_f32 v11, v64, v65, v11
    v_max3_f32 v11, v66, v67, v11
    v_max3_f32 v11, v68, v69, v11
    v_max3_f32 v11, v70, v71, v11
    v_max3_f32 v11, v72, v73, v11
    v_max3_f32 v11, v74, v75, v11
    v_max3_f32 v11, v76, v77, v11
    v_max3_f32 v11, v78, v79, v11
    s_cmp_eq_u32 s21, 4
    s_cbranch_scc1 L_b_exact_done
    ds_read_b128 v[32:35], v4 offset:10240
    ds_read_b64 v[36:37], v5 offset:10240
    s_waitcnt lgkmcnt(0)
    v_mfma_f32_32x32x16_bf16 v[64:79], v[32:35], v[16:19], 0
    v_mfma_f32_32x32x8_bf16 v[64:79], v[36:37], v[20:21], v[64:79]
    s_nop 15
    v_max3_f32 v11, v64, v65, v11
    v_max3_f32 v11, v66, v67, v11
    v_max3_f32 v11, v68, v69, v11
    v_max3_f32 v11, v70, v71, v11
    v_max3_f32 v11, v72, v73, v11
    v_max3_f32 v11, v74, v75, v11
    v_max3_f32 v11, v76, v77, v11
    v_max3_f32 v11, v78, v79, v11
    s_cmp_eq_u32 s21, 5
    s_cbranch_scc1 L_b_exact_done
    ds_read_b128 v[32:35], v4 offset:7680
    ds_read_b64 v[36:37], v5 offset:7680
    s_waitcnt lgkmcnt(0)
    v_mfma_f32_32x32x16_bf16 v[64:79], v[32:35], v[16:19], 0
    v_mfma_f32_32x32x8_bf16 v[64:79], v[36:37], v[20:21], v[64:79]
    s_nop 15
    v_max3_f32 v11, v64, v65, v11
    v_max3_f32 v11, v66, v67, v11
    v_max3_f32 v11, v68, v69, v11
    v_max3_f32 v11, v70, v71, v11
    v_max3_f32 v11, v72, v73, v11
    v_max3_f32 v11, v74, v75, v11
    v_max3_f32 v11, v76, v77, v11
    v_max3_f32 v11, v78, v79, v11
    s_cmp_eq_u32 s21, 6
    s_cbranch_scc1 L_b_exact_done
    ds_read_b128 v[32:35], v4 offset:5120
    ds_read_b64 v[36:37], v5 offset:5120
    s_waitcnt lgkmcnt(0)
    v_mfma_f32_32x32x16_bf16 v[64:79], v[32:35], v[16:19], 0
    v_mfma_f32_32x32x8_bf16 v[64:79], v[36:37], v[20:21], v[64:79]
    s_nop 15
    v_max3_f32 v11, v64, v65, v11
    v_max3_f32 v11, v66, v67, v11
    v_max3_f32 v11, v68, v69, v11
    v_max3_f32 v11, v70, v71, v11
    v_max3_f32 v11, v72, v73, v11
    v_max3_f32 v11, v74, v75, v11
    v_max3_f32 v11, v76, v77, v11
    v_max3_f32 v11, v78, v79, v11
    s_cmp_eq_u32 s21, 7
    s_cbranch_scc1 L_b_exact_done
    ds_read_b128 v[32:35], v4 offset:2560
    ds_read_b64 v[36:37], v5 offset:2560
    s_waitcnt lgkmcnt(0)
    v_mfma_f32_32x32x16_bf16 v[64:79], v[32:35], v[16:19], 0
    v_mfma_f32_32x32x8_bf16 v[64:79], v[36:37], v[20:21], v[64:79]
    s_nop 15
    v_max3_f32 v11, v64, v65, v11
    v_max3_f32 v11, v66, v67, v11
    v_max3_f32 v11, v68, v69, v11
    v_max3_f32 v11, v70, v71, v11
    v_max3_f32 v11, v72, v73, v11
    v_max3_f32 v11, v74, v75, v11
    v_max3_f32 v11, v76, v77, v11
    v_max3_f32 v11, v78, v79, v11
    s_cmp_eq_u32 s21, 8
    s_cbranch_scc1 L_b_exact_done
    ds_read_b128 v[32:35], v4 offset:0
    ds_read_b64 v[36:37], v5 offset:0
    s_waitcnt lgkmcnt(0)
    v_mfma_f32_32x32x16_bf16 v[64:79], v[32:35], v[16:19], v[144:159]
    v_mfma_f32_32x32x8_bf16 v[64:79], v[36:37], v[20:21], v[64:79]
    s_nop 15
    v_max3_f32 v11, v64, v65, v11
    v_max3_f32 v11, v66, v67, v11
    v_max3_f32 v11, v68, v69, v11
    v_max3_f32 v11, v70, v71, v11
    v_max3_f32 v11, v72, v73, v11
    v_max3_f32 v11, v74, v75, v11
    v_max3_f32 v11, v76, v77, v11
    v_max3_f32 v11, v78, v79, v11
L_b_exact_done:
    v_mov_b32 v13, v11
    s_nop 1
    v_permlane32_swap_b32 v13, v11
    s_nop 1
    v_max_f32_e64 v11, v11, v13
    v_sub_f32 v11, 0xc2200000, v11
    s_branch L_b_start
L_attn_end:
    s_endpgm
L_text_end:
.section .rodata,"a"

.p2align 6
.amdhsa_kernel qkv_kernel
  .amdhsa_next_free_vgpr 256
  .amdhsa_next_free_sgpr 96
  .amdhsa_accum_offset 256
  .amdhsa_group_segment_fixed_size 0
  .amdhsa_kernarg_size 72
  .amdhsa_user_sgpr_count 2
  .amdhsa_user_sgpr_kernarg_segment_ptr 1
  .amdhsa_system_sgpr_workgroup_id_x 1
.end_amdhsa_kernel

.p2align 6
.amdhsa_kernel attn_kernel
  .amdhsa_next_free_vgpr 256
  .amdhsa_next_free_sgpr 100
  .amdhsa_accum_offset 256
  .amdhsa_group_segment_fixed_size 0
  .amdhsa_kernarg_size 72
  .amdhsa_user_sgpr_count 2
  .amdhsa_user_sgpr_kernarg_segment_ptr 1
  .amdhsa_system_sgpr_workgroup_id_x 1
.end_amdhsa_kernel
```
